```python
import torch

def _softmax(x, axis=-1):
    return torch.softmax(x, dim=axis)

def _gelu(x):
    return torch.nn.functional.gelu(x, approximate='tanh')

def _silu(x):
    return torch.nn.functional.silu(x)

def _sigmoid(x):
    return torch.sigmoid(x)

def _layernorm(x, axis=-1, eps=1e-05):
    m = x.mean(dim=axis, keepdim=True)
    v = x.var(dim=axis, keepdim=True, unbiased=False)
    return (x - m) / torch.sqrt(v + eps)

def _scatter_add(tgt, idx, src, axis=0):
    return tgt.clone().index_add_(axis, idx, src)

def _segment_sum(src, seg, n):
    out = torch.zeros((n,) + src.shape[1:], dtype=src.dtype)
    return out.index_add_(0, seg, src)

def _pad(x, pw):
    flat = tuple((v for pair in reversed(pw) for v in pair))
    return torch.nn.functional.pad(x, flat)
kernel_name = 'standalone__tensor_product_equiv_equiformer__graph'

def setup_inputs():

    _w = lambda a: (lambda t: t.to(torch.bfloat16) if t.is_floating_point() else t)(torch.as_tensor(a))
    N, deg, C, De = (50000, 16, 64, max(16, 1))
    E = N * deg
    src = (lambda lo, hi, *s: torch.randint(lo, hi, s))(0, N, E).to(torch.int64)
    dst = (lambda lo, hi, *s: torch.randint(lo, hi, s))(0, N, E).to(torch.int64)
    rvec = (lambda *s: torch.randn(*s, dtype=torch.bfloat16) * 0.05)(E, 3).to(float)
    rn = (torch.linalg.norm(rvec, dim=-1, keepdim=True) + 1e-06).to(float)
    rhat = (rvec / rn).to(float)
    eps = torch.zeros((3, 3, 3), dtype=float)
    eps[0, 1, 2] = eps[1, 2, 0] = eps[2, 0, 1] = 1.0
    eps[0, 2, 1] = eps[2, 1, 0] = eps[1, 0, 2] = -1.0
    return {'x': _w((lambda *s: torch.randn(*s, dtype=torch.bfloat16) * 0.2)(N, 4 * C).to(float)), 'rhat': _w(rhat), 'e_attr': _w((lambda *s: torch.randn(*s, dtype=torch.bfloat16) * 0.2)(E, De).to(float)), 'src': _w(src), 'dst': _w(dst), 'w_rad': _w((lambda *s: torch.randn(*s, dtype=torch.bfloat16) * 0.2)(De, 5 * C).to(float)), 'w_si0': _w((lambda *s: torch.randn(*s, dtype=torch.bfloat16) * 0.2)(2 * C, C).to(float)), 'w_si1': _w((lambda *s: torch.randn(*s, dtype=torch.bfloat16) * 0.05)(3 * C, C).to(float)), 'cg_eps': _w(eps)}

def reference(x, rhat, e_attr, src, dst, w_rad, w_si0, w_si1, cg_eps):
    N = x.shape[0]
    C = w_si0.shape[1]
    E = rhat.shape[0]
    x0 = x[:, :C].clone()
    x1 = x[:, C:].reshape(N, 3, C)
    R = (e_attr @ w_rad).reshape(E, 5, C)
    f0 = x0[src]
    f1 = x1[src]
    Y1 = rhat
    p00_0 = f0 * R[:, 0, :]
    p11_0 = torch.einsum('ejc,ej->ec', f1, Y1) * R[:, 1, :]
    p01_1 = torch.einsum('ec,ej->ejc', f0, Y1) * R[:, 2, :][:, None, :]
    p10_1 = f1 * R[:, 3, :][:, None, :]
    p11_1 = torch.einsum('ijk,ekc,ej->eic', cg_eps, f1, Y1) * R[:, 4, :][:, None, :]
    m0 = torch.concatenate([p00_0, p11_0], axis=-1) @ w_si0
    m1 = torch.einsum('ejp,pc->ejc', torch.concatenate([p01_1, p10_1, p11_1], axis=-1), w_si1)
    agg0 = _segment_sum(m0, dst, N)
    agg1 = _segment_sum(m1.reshape(E, 3 * C), dst, N).reshape(N, 3, C)
    gate = _sigmoid(agg0)
    out1 = agg1 * gate[:, None, :]
    return torch.concatenate([agg0, out1.reshape(N, 3 * C)], axis=-1)
```

```asm
; @launch kernel=tp_sort_kernel grid=(254,1,1) block=(1024,1,1) lds=149248
; @launch kernel=tp_main_kernel grid=(256,1,1) block=(512,1,1) lds=163840
.amdgcn_target "amdgcn-amd-amdhsa--gfx950"
.text
.globl tp_sort_kernel
.p2align 8
.type tp_sort_kernel,@function
tp_sort_kernel:
    s_cmp_ge_u32 s2, 254
    s_cbranch_scc1 tp_sort_kernel_end
    s_load_dwordx8 s[4:11], s[0:1], 8
    s_load_dwordx2 s[12:13], s[0:1], 88
    s_cmp_ge_u32 s2, 250
    s_cbranch_scc1 tp_sort_kernel_weights
    v_lshrrev_b32 v1, 6, v0
    v_lshlrev_b32 v2, 4, v0
    v_readfirstlane_b32 s3, v1
    v_mul_u32_u24 v3, 24, v0
    v_and_b32 v4, 63, v0
    v_lshlrev_b32 v4, 4, v4
    v_mov_b32 v5, 0
    v_lshlrev_b32 v6, 2, v0
    s_mul_i32 s40, s2, 12800
    s_mul_i32 s41, s2, 19200
    s_mul_i32 s42, s2, 102400
    s_mul_i32 s43, s2, 25600
    s_mul_i32 s44, s2, 3200
    s_lshl_b32 s62, s3, 10
    s_add_u32 s63, s62, s42
    v_and_b32 v7, 0x7fc, v6
    v_add_u32 v7, 147200, v7
    ds_write_b32 v7, v5
    v_cmp_gt_u32 vcc, 800, v0
    s_and_b64 exec, exec, vcc
    s_mov_b64 s[52:53], exec
    s_mov_b32 s18, 0x30d400
    s_mov_b32 s19, 0x20000
    s_mov_b32 s22, 0x30d400
    s_mov_b32 s23, 0x20000
    s_mov_b32 s26, 0x493e00
    s_mov_b32 s27, 0x20000
    s_mov_b32 s30, 0x186a000
    s_mov_b32 s31, 0x20000
    s_waitcnt lgkmcnt(0)
    s_mov_b64 s[16:17], s[10:11]
    s_mov_b64 s[20:21], s[8:9]
    s_mov_b64 s[24:25], s[4:5]
    s_mov_b64 s[28:29], s[6:7]
    s_cbranch_execz tp_sort_kernel_noload
    buffer_load_dwordx4 v[8:11], v2, s[16:19], s40 offen nt
    buffer_load_dwordx4 v[12:15], v2, s[20:23], s40 offen nt
    buffer_load_dwordx4 v[16:19], v3, s[24:27], s41 offen nt
    buffer_load_dwordx2 v[20:21], v3, s[24:27], s41 offen offset:16 nt
tp_sort_kernel_noload:
    s_mov_b64 exec, -1
    s_barrier
    s_cmp_lt_u32 s3, 12
    s_cbranch_scc1 tp_sort_kernel_noextra
    s_add_u32 m0, s62, 86016
    s_add_u32 s14, s63, 86016
    buffer_load_dwordx4 v4, s[28:31], s14 offen nt lds
tp_sort_kernel_noextra:
    s_mov_b32 m0, s62
    s_add_u32 s62, s62, 0x4000
    buffer_load_dwordx4 v4, s[28:31], s63 offen nt lds
    s_add_u32 s63, s63, 0x4000
    s_mov_b32 m0, s62
    s_add_u32 s62, s62, 0x4000
    buffer_load_dwordx4 v4, s[28:31], s63 offen nt lds
    s_add_u32 s63, s63, 0x4000
    s_mov_b32 m0, s62
    s_add_u32 s62, s62, 0x4000
    buffer_load_dwordx4 v4, s[28:31], s63 offen nt lds
    s_add_u32 s63, s63, 0x4000
    s_mov_b32 s32, s12
    s_mov_b32 s33, s13
    s_mov_b32 s34, 0x186a000
    s_mov_b32 s35, 0x20000
    s_add_u32 s36, s12, 0x1900000
    s_addc_u32 s37, s13, 0
    s_mov_b32 s38, 0x61a800
    s_mov_b32 s39, 0x20000
    s_add_u32 s56, s12, 0x1f1a800
    s_addc_u32 s57, s13, 0
    s_mov_b32 s58, 0x30d400
    s_mov_b32 s59, 0x20000
    s_add_u32 s48, s12, 0x2300000
    s_addc_u32 s49, s13, 0
    s_mov_b32 s50, 0x3e800
    s_mov_b32 s51, 0x20000
    s_cmp_lt_u32 s3, 13
    s_cbranch_scc1 tp_sort_kernel_nocode
    s_cmp_ge_u32 s2, 16
    s_cbranch_scc1 tp_sort_kernel_nocode
    s_getpc_b64 s[64:65]
tp_sort_kernel_pc:
    s_add_u32 s64, s64, tp_main_kernel - tp_sort_kernel_pc
    s_addc_u32 s65, s65, 0
    s_lshr_b32 s66, s2, 3
    s_mul_i32 s66, s66, 192
    s_sub_u32 s66, s66, 832
    v_add_u32 v60, s66, v0
    v_min_u32 v60, 209, v60
    v_lshlrev_b32 v60, 7, v60
    v_mov_b32 v61, s65
    v_add_co_u32 v60, vcc, s64, v60
    s_nop 1
    v_addc_co_u32 v61, vcc, 0, v61, vcc
    global_load_dword v61, v[60:61], off
tp_sort_kernel_nocode:
    s_waitcnt vmcnt(5)
    s_mov_b64 exec, s[52:53]
    s_cbranch_execz tp_sort_kernel_nohist
    v_mov_b32 v5, 1
    s_mov_b32 s14, 147200
    s_mov_b32 s15, 148224
    v_and_b32 v24, 0xff, v8
    v_lshrrev_b32 v28, 12, v12
    v_bfe_u32 v1, v8, 5, 3
    v_lshl_add_u32 v24, v24, 2, s14
    v_lshl_add_u32 v28, v1, 5, v28
    ds_add_rtn_u32 v32, v24, v5
    v_lshl_add_u32 v28, v28, 2, s15
    ds_add_rtn_u32 v36, v28, v5
    v_and_b32 v25, 0xff, v9
    v_lshrrev_b32 v29, 12, v13
    v_bfe_u32 v1, v9, 5, 3
    v_lshl_add_u32 v25, v25, 2, s14
    v_lshl_add_u32 v29, v1, 5, v29
    ds_add_rtn_u32 v33, v25, v5
    v_lshl_add_u32 v29, v29, 2, s15
    ds_add_rtn_u32 v37, v29, v5
    v_and_b32 v26, 0xff, v10
    v_lshrrev_b32 v30, 12, v14
    v_bfe_u32 v1, v10, 5, 3
    v_lshl_add_u32 v26, v26, 2, s14
    v_lshl_add_u32 v30, v1, 5, v30
    ds_add_rtn_u32 v34, v26, v5
    v_lshl_add_u32 v30, v30, 2, s15
    ds_add_rtn_u32 v38, v30, v5
    v_and_b32 v27, 0xff, v11
    v_lshrrev_b32 v31, 12, v15
    v_bfe_u32 v1, v11, 5, 3
    v_lshl_add_u32 v27, v27, 2, s14
    v_lshl_add_u32 v31, v1, 5, v31
    ds_add_rtn_u32 v35, v27, v5
    v_lshl_add_u32 v31, v31, 2, s15
    ds_add_rtn_u32 v39, v31, v5
tp_sort_kernel_nohist:
    s_mov_b64 exec, -1
    s_mov_b32 m0, s62
    s_add_u32 s62, s62, 0x4000
    buffer_load_dwordx4 v4, s[28:31], s63 offen nt lds
    s_add_u32 s63, s63, 0x4000
    s_mov_b32 m0, s62
    s_add_u32 s62, s62, 0x4000
    buffer_load_dwordx4 v4, s[28:31], s63 offen nt lds
    s_add_u32 s63, s63, 0x4000
    s_waitcnt lgkmcnt(0)
    s_barrier
    s_cmp_ge_u32 s3, 2
    s_cbranch_scc1 tp_sort_kernel_noscan
    v_add_u32 v7, 147200, v2
    ds_read_b128 v[40:43], v7
    s_waitcnt lgkmcnt(0)
    v_add_u32 v45, v40, v41
    v_add_u32 v46, v45, v42
    v_add_u32 v47, v46, v43
    v_mov_b32 v44, v47
    s_nop 1
    v_add_u32_dpp v44, v44, v44 row_shr:1 row_mask:0xf bank_mask:0xf bound_ctrl:0
    s_nop 1
    v_add_u32_dpp v44, v44, v44 row_shr:2 row_mask:0xf bank_mask:0xf bound_ctrl:0
    s_nop 1
    v_add_u32_dpp v44, v44, v44 row_shr:4 row_mask:0xf bank_mask:0xf bound_ctrl:0
    s_nop 1
    v_add_u32_dpp v44, v44, v44 row_shr:8 row_mask:0xf bank_mask:0xf bound_ctrl:0
    s_nop 1
    v_add_u32_dpp v44, v44, v44 row_bcast:15 row_mask:0xa bank_mask:0xf
    s_nop 1
    v_add_u32_dpp v44, v44, v44 row_bcast:31 row_mask:0xc bank_mask:0xf
    v_sub_u32 v44, v44, v47
    v_add_u32 v47, v44, v46
    v_add_u32 v46, v44, v45
    v_add_u32 v45, v44, v40
    ds_write_b128 v7, v[44:47]
    s_cmp_eq_u32 s3, 0
    s_cbranch_scc0 tp_sort_kernel_noscan
    v_lshl_or_b32 v40, v40, 16, v44
    v_lshl_or_b32 v41, v41, 16, v45
    v_lshl_or_b32 v42, v42, 16, v46
    v_lshl_or_b32 v43, v43, 16, v47
    s_lshl_b32 s14, s2, 10
    buffer_store_dwordx4 v[40:43], v2, s[48:51], s14 offen sc1
tp_sort_kernel_noscan:
    s_mov_b32 m0, s62
    s_add_u32 s62, s62, 0x4000
    buffer_load_dwordx4 v4, s[28:31], s63 offen nt lds
    s_add_u32 s63, s63, 0x4000
    s_waitcnt lgkmcnt(0)
    s_barrier
    s_mov_b64 exec, s[52:53]
    s_cbranch_execz tp_sort_kernel_noplace
    ds_read_b32 v24, v24
    ds_read_b32 v28, v28
    ds_read_b32 v25, v25
    ds_read_b32 v29, v29
    ds_read_b32 v26, v26
    ds_read_b32 v30, v30
    ds_read_b32 v27, v27
    ds_read_b32 v31, v31
    s_waitcnt vmcnt(6)
    s_mov_b32 s14, 0x05040100
    s_mov_b32 s15, 0x05040302
    s_mov_b32 s45, 0x0c050100
    s_mov_b32 s46, 0x06020100
    v_mov_b32 v48, v16
    v_alignbit_b32 v50, v18, v17, 16
    v_mov_b32 v52, v19
    v_alignbit_b32 v54, v21, v20, 16
    v_perm_b32 v12, v8, v12, s45
    v_perm_b32 v13, v9, v13, s45
    v_perm_b32 v14, v10, v14, s45
    v_perm_b32 v15, v11, v15, s45
    s_mov_b32 s47, 102400
    s_mov_b32 s60, 128000
    s_mov_b32 s61, 140800
    s_waitcnt lgkmcnt(0)
    v_add_u32 v24, v24, v32
    v_add_u32 v28, v28, v36
    v_add_u32 v23, s44, v28
    v_lshl_add_u32 v22, v24, 3, s47
    v_perm_b32 v49, v23, v17, s14
    v_perm_b32 v23, v23, v12, s46
    v_lshl_add_u32 v24, v24, 2, s60
    v_lshl_add_u32 v28, v28, 1, s61
    v_add_u32 v1, 0, v6
    ds_write_b64 v22, v[48:49]
    ds_write_b32 v24, v23
    ds_write_b16 v28, v1
    v_add_u32 v25, v25, v33
    v_add_u32 v29, v29, v37
    v_add_u32 v23, s44, v29
    v_lshl_add_u32 v22, v25, 3, s47
    v_perm_b32 v51, v23, v18, s15
    v_perm_b32 v23, v23, v13, s46
    v_lshl_add_u32 v25, v25, 2, s60
    v_lshl_add_u32 v29, v29, 1, s61
    v_add_u32 v1, 1, v6
    ds_write_b64 v22, v[50:51]
    ds_write_b32 v25, v23
    ds_write_b16 v29, v1
    v_add_u32 v26, v26, v34
    v_add_u32 v30, v30, v38
    v_add_u32 v23, s44, v30
    v_lshl_add_u32 v22, v26, 3, s47
    v_perm_b32 v53, v23, v20, s14
    v_perm_b32 v23, v23, v14, s46
    v_lshl_add_u32 v26, v26, 2, s60
    v_lshl_add_u32 v30, v30, 1, s61
    v_add_u32 v1, 2, v6
    ds_write_b64 v22, v[52:53]
    ds_write_b32 v26, v23
    ds_write_b16 v30, v1
    v_add_u32 v27, v27, v35
    v_add_u32 v31, v31, v39
    v_add_u32 v23, s44, v31
    v_lshl_add_u32 v22, v27, 3, s47
    v_perm_b32 v55, v23, v21, s15
    v_perm_b32 v23, v23, v15, s46
    v_lshl_add_u32 v27, v27, 2, s60
    v_lshl_add_u32 v31, v31, 1, s61
    v_add_u32 v1, 3, v6
    ds_write_b64 v22, v[54:55]
    ds_write_b32 v27, v23
    ds_write_b16 v31, v1
tp_sort_kernel_noplace:
    s_mov_b64 exec, -1
    s_waitcnt lgkmcnt(0)
    s_barrier
    v_add_u32 v7, 102400, v2
    ds_read_b128 v[8:11], v7
    ds_read_b128 v[12:15], v7 offset:16384
    ds_read_b128 v[16:19], v7 offset:25600
    v_and_b32 v1, 0x3fe, v0
    v_add_u32 v1, 140800, v1
    ds_read_u16 v24, v1 offset:0
    ds_read_u16 v25, v1 offset:1024
    ds_read_u16 v26, v1 offset:2048
    ds_read_u16 v27, v1 offset:3072
    ds_read_u16 v28, v1 offset:4096
    ds_read_u16 v29, v1 offset:5120
    ds_read_u16 v30, v1 offset:6144
    s_add_u32 s14, s43, 16384
    v_and_b32 v1, 1, v0
    v_lshlrev_b32 v1, 4, v1
    s_waitcnt lgkmcnt(0)
    v_lshl_add_u32 v24, v24, 5, v1
    v_lshl_add_u32 v25, v25, 5, v1
    v_lshl_add_u32 v26, v26, 5, v1
    v_lshl_add_u32 v27, v27, 5, v1
    v_lshl_add_u32 v28, v28, 5, v1
    v_lshl_add_u32 v29, v29, 5, v1
    v_lshl_add_u32 v30, v30, 5, v1
    buffer_store_dwordx4 v[8:11], v2, s[36:39], s43 offen sc1
    s_mov_b64 exec, s[52:53]
    s_cbranch_execz tp_sort_kernel_wait1
    buffer_store_dwordx4 v[16:19], v2, s[56:59], s40 offen sc1
    s_cmp_ge_u32 s3, 9
    s_cbranch_scc1 tp_sort_kernel_wait2
    buffer_store_dwordx4 v[12:15], v2, s[36:39], s14 offen sc1
    s_waitcnt vmcnt(3)
    s_branch tp_sort_kernel_landed
tp_sort_kernel_wait1:
    s_waitcnt vmcnt(1)
tp_sort_kernel_wait2:
    s_waitcnt vmcnt(2)
tp_sort_kernel_landed:
    s_mov_b64 exec, -1
    s_barrier
    ds_read_b128 v[32:35], v24
    ds_read_b128 v[36:39], v25
    ds_read_b128 v[40:43], v26
    ds_read_b128 v[44:47], v27
    ds_read_b128 v[48:51], v28
    ds_read_b128 v[52:55], v29
    s_cmp_ge_u32 s3, 4
    s_cbranch_scc1 tp_sort_kernel_no7
    ds_read_b128 v[56:59], v30
    s_add_u32 s14, s42, 98304
    s_waitcnt lgkmcnt(0)
    buffer_store_dwordx4 v[56:59], v2, s[32:35], s14 offen sc1
tp_sort_kernel_no7:
    s_waitcnt lgkmcnt(5)
    buffer_store_dwordx4 v[32:35], v2, s[32:35], s42 offen sc1
    s_add_u32 s42, s42, 16384
    s_waitcnt lgkmcnt(4)
    buffer_store_dwordx4 v[36:39], v2, s[32:35], s42 offen sc1
    s_add_u32 s42, s42, 16384
    s_waitcnt lgkmcnt(3)
    buffer_store_dwordx4 v[40:43], v2, s[32:35], s42 offen sc1
    s_add_u32 s42, s42, 16384
    s_waitcnt lgkmcnt(2)
    buffer_store_dwordx4 v[44:47], v2, s[32:35], s42 offen sc1
    s_add_u32 s42, s42, 16384
    s_waitcnt lgkmcnt(1)
    buffer_store_dwordx4 v[48:51], v2, s[32:35], s42 offen sc1
    s_add_u32 s42, s42, 16384
    s_waitcnt lgkmcnt(0)
    buffer_store_dwordx4 v[52:55], v2, s[32:35], s42 offen sc1
    s_add_u32 s42, s42, 16384
    s_endpgm
tp_sort_kernel_weights:
    s_load_dwordx4 s[56:59], s[0:1], 40
    s_load_dwordx2 s[60:61], s[0:1], 56
    s_sub_u32 s3, s2, 250
    s_lshl_b32 s3, s3, 4
    v_lshrrev_b32 v1, 6, v0
    v_and_b32 v2, 31, v0
    v_readfirstlane_b32 s14, v1
    v_bfe_u32 v3, v0, 5, 1
    s_add_u32 s3, s3, s14
    s_waitcnt lgkmcnt(0)
    s_mov_b32 s16, s56
    s_mov_b32 s17, s57
    s_mov_b32 s18, 0x2800
    s_mov_b32 s19, 0x20000
    s_mov_b32 s20, s58
    s_mov_b32 s21, s59
    s_mov_b32 s22, 0x4000
    s_mov_b32 s23, 0x20000
    s_mov_b32 s24, s60
    s_mov_b32 s25, s61
    s_mov_b32 s26, 0x6000
    s_mov_b32 s27, 0x20000
    s_add_u32 s28, s12, 0x2380000
    s_addc_u32 s29, s13, 0
    s_mov_b32 s30, 0xc800
    s_mov_b32 s31, 0x20000
    s_cmp_ge_u32 s3, 50
    s_cbranch_scc1 tp_sort_kernel_end
    v_and_b32 v5, 63, v0
    v_lshlrev_b32 v5, 4, v5
    s_lshl_b32 s40, s3, 10
    s_cmp_ge_u32 s3, 10
    s_cbranch_scc1 tp_sort_kernel_wsi
    v_mul_u32_u24 v4, 5120, v3
    v_lshl_add_u32 v4, v2, 1, v4
    s_lshl_b32 s15, s3, 6
    buffer_load_ushort v8, v4, s[16:19], s15 offen
    s_add_u32 s15, s15, 640
    buffer_load_ushort v9, v4, s[16:19], s15 offen
    s_add_u32 s15, s15, 640
    buffer_load_ushort v10, v4, s[16:19], s15 offen
    s_add_u32 s15, s15, 640
    buffer_load_ushort v11, v4, s[16:19], s15 offen
    s_add_u32 s15, s15, 640
    buffer_load_ushort v12, v4, s[16:19], s15 offen
    s_add_u32 s15, s15, 640
    buffer_load_ushort v13, v4, s[16:19], s15 offen
    s_add_u32 s15, s15, 640
    buffer_load_ushort v14, v4, s[16:19], s15 offen
    s_add_u32 s15, s15, 640
    buffer_load_ushort v15, v4, s[16:19], s15 offen
    s_add_u32 s15, s15, 640
    s_branch tp_sort_kernel_wpack
tp_sort_kernel_wsi:
    s_sub_u32 s14, s3, 10
    v_lshlrev_b32 v4, 10, v3
    v_lshl_add_u32 v4, v2, 2, v4
    s_and_b32 s15, s14, 1
    s_lshl_b32 s15, s15, 1
    s_lshr_b32 s14, s14, 1
    s_lshl_b32 s41, s14, 11
    s_add_u32 s15, s15, s41
    s_cmp_ge_u32 s14, 8
    s_cbranch_scc1 tp_sort_kernel_wsi1
    buffer_load_ushort v8, v4, s[20:23], s15 offen offset:0
    buffer_load_ushort v9, v4, s[20:23], s15 offen offset:128
    buffer_load_ushort v10, v4, s[20:23], s15 offen offset:256
    buffer_load_ushort v11, v4, s[20:23], s15 offen offset:384
    buffer_load_ushort v12, v4, s[20:23], s15 offen offset:512
    buffer_load_ushort v13, v4, s[20:23], s15 offen offset:640
    buffer_load_ushort v14, v4, s[20:23], s15 offen offset:768
    buffer_load_ushort v15, v4, s[20:23], s15 offen offset:896
    s_branch tp_sort_kernel_wpack
tp_sort_kernel_wsi1:
    s_sub_u32 s15, s15, 16384
    buffer_load_ushort v8, v4, s[24:27], s15 offen offset:0
    buffer_load_ushort v9, v4, s[24:27], s15 offen offset:128
    buffer_load_ushort v10, v4, s[24:27], s15 offen offset:256
    buffer_load_ushort v11, v4, s[24:27], s15 offen offset:384
    buffer_load_ushort v12, v4, s[24:27], s15 offen offset:512
    buffer_load_ushort v13, v4, s[24:27], s15 offen offset:640
    buffer_load_ushort v14, v4, s[24:27], s15 offen offset:768
    buffer_load_ushort v15, v4, s[24:27], s15 offen offset:896
tp_sort_kernel_wpack:
    s_waitcnt vmcnt(0)
    v_lshl_or_b32 v16, v9, 16, v8
    v_lshl_or_b32 v17, v11, 16, v10
    v_lshl_or_b32 v18, v13, 16, v12
    v_lshl_or_b32 v19, v15, 16, v14
    buffer_store_dwordx4 v[16:19], v5, s[28:31], s40 offen sc1
tp_sort_kernel_end:
    s_endpgm
.globl tp_main_kernel
.p2align 8
.type tp_main_kernel,@function
tp_main_kernel:
    s_cmp_ge_u32 s2, 256
    s_cbranch_scc1 tp_main_kernel_end
    s_load_dwordx2 s[72:73], s[0:1], 0
    s_load_dwordx2 s[74:75], s[0:1], 72
    s_load_dwordx2 s[76:77], s[0:1], 88
    v_lshrrev_b32 v1, 6, v0
    s_and_b32 s32, s2, 7
    v_readfirstlane_b32 s3, v1
    s_lshl_b32 s32, s32, 5
    s_lshr_b32 s48, s2, 3
    s_add_u32 s32, s32, s48
    s_mul_i32 s33, s3, 13440
    s_add_u32 s33, s33, 56320
    s_mov_b32 s68, 0
    s_mov_b32 s69, 0x80000000
    s_mov_b32 s34, 0
tp_main_kernel_window:
    v_mbcnt_lo_u32_b32 v16, -1, 0
    v_mbcnt_hi_u32_b32 v16, -1, v16
    v_lshlrev_b32 v0, 4, v16
    s_lshl_b32 s48, s3, 6
    v_add_u32 v17, s48, v16
    v_lshrrev_b32 v26, 1, v17
    v_lshlrev_b32 v19, 10, v26
    s_lshl_b32 s49, s32, 2
    s_waitcnt lgkmcnt(0)
    s_add_u32 s12, s76, 0x2300000
    s_addc_u32 s13, s77, 0
    s_mov_b32 s14, 0x3e800
    s_mov_b32 s15, 0x20000
    buffer_load_dword v27, v19, s[12:15], s49 offen
    v_mov_b32 v21, 0
    s_mov_b32 s4, s72
    s_mov_b32 s5, s73
    s_mov_b32 s6, 0x186a000
    s_mov_b32 s7, 0x20000
    s_mov_b32 s8, s76
    s_mov_b32 s9, s77
    s_mov_b32 s10, 0x186a000
    s_mov_b32 s11, 0x20000
    s_mov_b32 s16, s74
    s_mov_b32 s17, s75
    s_mov_b32 s18, 0x186a000
    s_mov_b32 s19, 0x20000
    s_add_u32 s20, s76, 0x2380000
    s_addc_u32 s21, s77, 0
    s_mov_b32 s22, 0xc800
    s_mov_b32 s23, 0x20000
    s_add_u32 s24, s76, 0x1900000
    s_addc_u32 s25, s77, 0
    s_mov_b32 s26, 0x61a800
    s_mov_b32 s27, 0x20000
    s_add_u32 s84, s76, 0x1f1a800
    s_addc_u32 s85, s77, 0
    s_mov_b32 s86, 0x30d400
    s_mov_b32 s87, 0x20000
    s_add_u32 s28, s76, 0x2600000
    s_addc_u32 s29, s77, 0
    s_mov_b32 s30, 0x4000000
    s_mov_b32 s31, 0x20000
    s_add_u32 s88, s76, 0x2400000
    s_addc_u32 s89, s77, 0
    s_mov_b32 s90, 0x200000
    s_mov_b32 s91, 0x20000
    v_lshlrev_b32 v22, 2, v17
    ds_write_b32 v22, v21 offset:56320
    v_lshlrev_b32 v22, 2, v16
    v_mov_b32 v23, -1
    v_mov_b32 v63, v17
    s_cmp_lg_u32 s3, 7
    s_cbranch_scc1 tp_main_kernel_nomt
    ds_write_b32 v22, v21 offset:60416
    ds_write_b32 v22, v23 offset:10496
    s_mov_b32 s49, 0x5040c0c
    v_writelane_b32 v21, s49, 0
    s_mov_b32 s49, 0x3020c0c
    v_writelane_b32 v21, s49, 1
    s_mov_b32 s49, 0x80000000
    v_writelane_b32 v21, s49, 2
    s_mov_b32 s49, 0xc0c0504
    v_writelane_b32 v21, s49, 4
    s_mov_b32 s49, 0x1000c0c
    v_writelane_b32 v21, s49, 5
    s_mov_b32 s49, 0x8000
    v_writelane_b32 v21, s49, 6
    s_mov_b32 s49, 0x1000302
    v_writelane_b32 v21, s49, 8
    s_mov_b32 s49, 0xc0c0c0c
    v_writelane_b32 v21, s49, 9
    s_mov_b32 s49, 0x8000
    v_writelane_b32 v21, s49, 10
    s_mov_b32 s49, 0x3020100
    v_writelane_b32 v21, s49, 12
    s_mov_b32 s49, 0x5040c0c
    v_writelane_b32 v21, s49, 13
    s_mov_b32 s49, 0xc0c0100
    v_writelane_b32 v21, s49, 16
    s_mov_b32 s49, 0xc0c0302
    v_writelane_b32 v21, s49, 18
    s_mov_b32 s49, 0xc0c0504
    v_writelane_b32 v21, s49, 20
    s_mov_b32 s49, 0xc0c0c0c
    v_writelane_b32 v21, s49, 22
    s_mov_b32 s49, 0x3f80
    v_writelane_b32 v21, s49, 23
    s_mov_b32 s49, 0x1000c0c
    v_writelane_b32 v21, s49, 24
    s_mov_b32 s49, 0x3020c0c
    v_writelane_b32 v21, s49, 26
    s_mov_b32 s49, 0x5040c0c
    v_writelane_b32 v21, s49, 28
    s_mov_b32 s49, 0xc0c0c0c
    v_writelane_b32 v21, s49, 30
    s_mov_b32 s49, 0x3f800000
    v_writelane_b32 v21, s49, 31
    ds_write_b32 v22, v21 offset:10240
tp_main_kernel_nomt:
    v_lshrrev_b32 v17, 3, v16
    v_bfe_u32 v2, v17, 1, 2
    v_and_b32 v18, 1, v17
    v_lshl_or_b32 v2, v18, 2, v2
    v_and_or_b32 v2, v17, 24, v2
    v_lshrrev_b32 v17, 2, v16
    v_bfe_u32 v3, v17, 1, 2
    v_and_b32 v18, 1, v17
    v_lshl_or_b32 v3, v18, 2, v3
    v_and_or_b32 v3, v17, 24, v3
    v_lshrrev_b32 v17, 1, v16
    v_bfe_u32 v4, v17, 1, 2
    v_and_b32 v18, 1, v17
    v_lshl_or_b32 v4, v18, 2, v4
    v_and_or_b32 v4, v17, 24, v4
    v_and_b32 v14, 0x70, v0
    v_bfe_u32 v17, v16, 3, 2
    v_and_b32 v18, 3, v16
    v_lshl_or_b32 v17, v17, 2, v18
    v_lshlrev_b32 v17, 5, v17
    v_lshrrev_b32 v18, 5, v16
    v_lshl_or_b32 v17, v18, 4, v17
    v_bfe_u32 v18, v16, 2, 1
    v_mul_u32_u24 v18, 262160, v18
    v_xor_b32 v17, v18, v17
    s_add_u32 s48, s33, 12416
    v_add_u32 v5, s48, v17
    v_xor_b32 v17, 262160, v17
    v_add_u32 v80, s48, v17
    v_lshrrev_b32 v18, 4, v16
    v_lshlrev_b32 v17, 5, v18
    v_and_b32 v18, 3, v16
    v_lshl_add_u32 v17, v18, 3, v17
    v_add_u32 v17, s33, v17
    v_bfe_u32 v18, v16, 2, 2
    v_min_u32 v19, 2, v18
    v_mul_u32_u24 v19, 4160, v19
    v_cmp_eq_u32 vcc, 2, v18
    v_mov_b32 v20, 262336
    v_bfe_u32 v21, v16, 3, 1
    v_cndmask_b32 v19, v19, v20, vcc
    v_add_u32 v1, v17, v19
    v_and_b32 v18, 1, v18
    v_cmp_eq_u32 vcc, 0, v18
    v_mul_u32_u24 v21, 4160, v21
    s_nop 0
    v_cndmask_b32 v21, v21, v20, vcc
    v_add_u32 v6, v17, v21
    s_getreg_b32 s83, hwreg(HW_REG_XCC_ID, 0, 3)
    s_mul_i32 s83, s83, 25
    s_add_u32 s83, s83, 8
    s_lshr_b32 s83, s83, 4
    s_lshr_b32 s79, s2, 3
    s_lshl_b32 s79, s79, 15
    s_lshl_b32 s48, s83, 21
    s_add_u32 s79, s79, s48
    s_sub_u32 s83, 16, s83
    s_lshl_b32 s83, s83, 12
    v_lshrrev_b32 v8, 3, v63
    v_and_b32 v15, 3, v63
    v_max_u32 v15, 1, v15
    v_lshlrev_b32 v15, 7, v15
    v_lshl_add_u32 v8, v8, 9, v15
    s_waitcnt vmcnt(0)
    buffer_load_dword v9, v8, s[4:7], s79 offen
    s_add_u32 s79, s79, 1048576
    s_lshl_b32 s49, s3, 10
    s_mov_b32 m0, s49
    s_and_b32 s50, s49, 1024
    buffer_load_dwordx4 v0, s[20:23], s49 offen lds
    s_add_u32 s50, s50, 8192
    s_mov_b32 m0, s50
    s_nop 0
    buffer_load_dwordx4 v0, s[20:23], s50 offen lds
    v_lshrrev_b32 v21, 16, v27
    v_and_b32 v20, 0xffff, v27
    v_and_b32 v23, 1, v16
    v_cmp_eq_u32 vcc, 0, v23
    s_nop 1
    v_cndmask_b32 v22, 0, v21, vcc
    s_nop 1
    v_add_u32_dpp v22, v22, v22 row_shr:1 row_mask:0xf bank_mask:0xf bound_ctrl:0
    s_nop 1
    v_add_u32_dpp v22, v22, v22 row_shr:2 row_mask:0xf bank_mask:0xf bound_ctrl:0
    s_nop 1
    v_add_u32_dpp v22, v22, v22 row_shr:4 row_mask:0xf bank_mask:0xf bound_ctrl:0
    s_nop 1
    v_add_u32_dpp v22, v22, v22 row_shr:8 row_mask:0xf bank_mask:0xf bound_ctrl:0
    s_nop 1
    v_add_u32_dpp v22, v22, v22 row_bcast:15 row_mask:0xa bank_mask:0xf
    s_nop 1
    v_add_u32_dpp v22, v22, v22 row_bcast:31 row_mask:0xc bank_mask:0xf
    s_nop 0
    v_readlane_b32 s48, v22, 63
    s_lshl_b32 s49, s3, 2
    s_add_u32 s49, s49, 60672
    v_mov_b32 v24, s49
    v_mov_b32 v25, s48
    ds_write_b32 v24, v25
    v_and_b32 v24, 7, v16
    v_lshlrev_b32 v24, 2, v24
    v_add_u32 v24, 60672, v24
    v_sub_u32 v22, v22, v21
    v_mul_u32_u24 v18, 3200, v26
    v_add_u32 v20, v20, v18
    s_waitcnt lgkmcnt(0)
    s_barrier
    ds_read_b32 v25, v24
    s_waitcnt lgkmcnt(0)
    s_nop 1
    v_add_u32_dpp v25, v25, v25 row_shr:1 row_mask:0xf bank_mask:0xf bound_ctrl:0
    s_nop 1
    v_add_u32_dpp v25, v25, v25 row_shr:2 row_mask:0xf bank_mask:0xf bound_ctrl:0
    s_nop 1
    v_add_u32_dpp v25, v25, v25 row_shr:4 row_mask:0xf bank_mask:0xf bound_ctrl:0
    s_nop 0
    v_readlane_b32 s35, v25, 7
    v_readlane_b32 s49, v25, s3
    s_sub_u32 s49, s49, s48
    s_sub_u32 s49, s49, s34
    s_sub_u32 s36, s35, s34
    s_min_u32 s36, s36, 3584
    v_add_u32 v22, s49, v22
    v_sub_u32 v24, 0, v22
    v_max_i32 v24, 0, v24
    v_sub_u32 v25, 3584, v22
    v_min_i32 v25, v25, v21
    v_add_u32 v24, v24, v23
    v_sub_u32 v20, v20, v22
    v_sub_u32 v25, v25, v24
    v_add_lshl_u32 v22, v22, v24, 2
tp_main_kernel_expand:
    v_cmpx_lt_i32 vcc, 0, v25
    s_cbranch_execz tp_main_kernel_expanded
    ds_write_b32 v22, v20 offset:60736
    v_cmpx_lt_i32 vcc, 2, v25
    ds_write_b32 v22, v20 offset:60744
    v_cmpx_lt_i32 vcc, 4, v25
    ds_write_b32 v22, v20 offset:60752
    v_cmpx_lt_i32 vcc, 6, v25
    ds_write_b32 v22, v20 offset:60760
    v_cmpx_lt_i32 vcc, 8, v25
    s_cbranch_execz tp_main_kernel_expanded
    ds_write_b32 v22, v20 offset:60768
    v_cmpx_lt_i32 vcc, 10, v25
    ds_write_b32 v22, v20 offset:60776
    v_cmpx_lt_i32 vcc, 12, v25
    ds_write_b32 v22, v20 offset:60784
    v_cmpx_lt_i32 vcc, 14, v25
    ds_write_b32 v22, v20 offset:60792
    v_add_u32 v22, 64, v22
    v_subrev_u32 v25, 16, v25
    s_branch tp_main_kernel_expand
tp_main_kernel_expanded:
    s_mov_b64 exec, -1
    v_lshlrev_b32 v22, 2, v63
    v_add_u32 v22, 60736, v22
    v_add_u32 v64, 0, v63
    v_cmp_gt_u32 s[52:53], s36, v64
    v_add_u32 v65, 512, v63
    v_cmp_gt_u32 s[54:55], s36, v65
    v_add_u32 v66, 1024, v63
    v_cmp_gt_u32 s[56:57], s36, v66
    v_add_u32 v67, 1536, v63
    v_cmp_gt_u32 s[58:59], s36, v67
    v_add_u32 v68, 2048, v63
    v_cmp_gt_u32 s[60:61], s36, v68
    v_add_u32 v69, 2560, v63
    v_cmp_gt_u32 s[62:63], s36, v69
    v_add_u32 v70, 3072, v63
    v_cmp_gt_u32 s[64:65], s36, v70
    v_bfrev_b32 v23, 2
    s_waitcnt lgkmcnt(0)
    s_barrier
    ds_read_b32 v56, v22 offset:0
    ds_read_b32 v57, v22 offset:2048
    ds_read_b32 v58, v22 offset:4096
    ds_read_b32 v59, v22 offset:6144
    ds_read_b32 v60, v22 offset:8192
    ds_read_b32 v61, v22 offset:10240
    ds_read_b32 v62, v22 offset:12288
    s_waitcnt lgkmcnt(6)
    v_add_lshl_u32 v56, v56, v64, 2
    v_cndmask_b32 v56, v23, v56, s[52:53]
    buffer_load_dword v26, v56, s[84:87], 0 offen
    s_waitcnt lgkmcnt(5)
    v_add_lshl_u32 v57, v57, v65, 2
    v_cndmask_b32 v57, v23, v57, s[54:55]
    buffer_load_dword v30, v57, s[84:87], 0 offen
    s_waitcnt lgkmcnt(4)
    v_add_lshl_u32 v58, v58, v66, 2
    v_cndmask_b32 v58, v23, v58, s[56:57]
    buffer_load_dword v34, v58, s[84:87], 0 offen
    s_waitcnt lgkmcnt(3)
    v_add_lshl_u32 v59, v59, v67, 2
    v_cndmask_b32 v59, v23, v59, s[58:59]
    buffer_load_dword v38, v59, s[84:87], 0 offen
    s_waitcnt lgkmcnt(2)
    v_add_lshl_u32 v60, v60, v68, 2
    v_cndmask_b32 v60, v23, v60, s[60:61]
    buffer_load_dword v42, v60, s[84:87], 0 offen
    s_waitcnt lgkmcnt(1)
    v_add_lshl_u32 v61, v61, v69, 2
    v_cndmask_b32 v61, v23, v61, s[62:63]
    buffer_load_dword v46, v61, s[84:87], 0 offen
    s_waitcnt lgkmcnt(0)
    v_add_lshl_u32 v62, v62, v70, 2
    v_cndmask_b32 v62, v23, v62, s[64:65]
    buffer_load_dword v50, v62, s[84:87], 0 offen
    v_lshlrev_b32 v72, 1, v56
    v_lshlrev_b32 v73, 1, v57
    v_lshlrev_b32 v74, 1, v58
    v_lshlrev_b32 v75, 1, v59
    v_lshlrev_b32 v76, 1, v60
    v_lshlrev_b32 v77, 1, v61
    v_lshlrev_b32 v78, 1, v62
    v_and_b32 v17, 48, v0
    ds_read_b128 v[10:13], v17 offset:10240
    v_mov_b32 v81, 0
    v_mov_b64 v[82:83], 0
    v_mov_b64 v[84:85], 0
    v_mov_b64 v[86:87], 0
    v_mov_b64 v[88:89], 0
    v_mov_b64 v[90:91], 0
    v_mov_b64 v[92:93], 0
    v_mov_b64 v[94:95], 0
    v_mov_b64 v[96:97], 0
    v_mov_b64 v[98:99], 0
    v_mov_b64 v[100:101], 0
    v_mov_b64 v[102:103], 0
    v_mov_b64 v[104:105], 0
    v_mov_b64 v[106:107], 0
    v_mov_b64 v[108:109], 0
    v_mov_b64 v[110:111], 0
    v_mov_b64 v[112:113], 0
    v_mov_b64 v[114:115], 0
    v_mov_b64 v[116:117], 0
    v_mov_b64 v[118:119], 0
    v_mov_b64 v[120:121], 0
    v_mov_b64 v[122:123], 0
    v_mov_b64 v[124:125], 0
    v_mov_b64 v[126:127], 0
    v_mov_b64 v[128:129], 0
    v_mov_b64 v[130:131], 0
    v_mov_b64 v[132:133], 0
    v_mov_b64 v[134:135], 0
    v_mov_b64 v[136:137], 0
    v_mov_b64 v[138:139], 0
    v_mov_b64 v[140:141], 0
    v_mov_b64 v[142:143], 0
    v_mov_b64 v[144:145], 0
    v_mov_b64 v[146:147], 0
    v_mov_b64 v[148:149], 0
    v_mov_b64 v[150:151], 0
    v_mov_b64 v[152:153], 0
    v_mov_b64 v[154:155], 0
    v_mov_b64 v[156:157], 0
    v_mov_b64 v[158:159], 0
    v_mov_b64 v[160:161], 0
    v_mov_b64 v[162:163], 0
    v_mov_b64 v[164:165], 0
    v_mov_b64 v[166:167], 0
    v_mov_b64 v[168:169], 0
    v_mov_b64 v[170:171], 0
    v_mov_b64 v[172:173], 0
    v_mov_b64 v[174:175], 0
    v_mov_b64 v[176:177], 0
    v_mov_b64 v[178:179], 0
    v_mov_b32 v23, 1
    s_waitcnt vmcnt(6)
    v_bfe_u32 v64, v26, 16, 8
    s_mov_b64 exec, s[52:53]
    v_lshlrev_b32 v64, 2, v64
    v_add_u32 v56, s83, v26
    ds_add_u32 v64, v23 offset:57344
    v_bfe_u32 v56, v56, 11, 5
    v_lshlrev_b32 v56, 2, v56
    s_waitcnt vmcnt(5)
    v_bfe_u32 v65, v30, 16, 8
    s_mov_b64 exec, s[54:55]
    v_lshlrev_b32 v65, 2, v65
    v_add_u32 v57, s83, v30
    ds_add_u32 v65, v23 offset:57344
    v_bfe_u32 v57, v57, 11, 5
    v_lshlrev_b32 v57, 2, v57
    s_waitcnt vmcnt(4)
    v_bfe_u32 v66, v34, 16, 8
    s_mov_b64 exec, s[56:57]
    v_lshlrev_b32 v66, 2, v66
    v_add_u32 v58, s83, v34
    ds_add_u32 v66, v23 offset:57344
    v_bfe_u32 v58, v58, 11, 5
    v_lshlrev_b32 v58, 2, v58
    s_waitcnt vmcnt(3)
    v_bfe_u32 v67, v38, 16, 8
    s_mov_b64 exec, s[58:59]
    v_lshlrev_b32 v67, 2, v67
    v_add_u32 v59, s83, v38
    ds_add_u32 v67, v23 offset:57344
    v_bfe_u32 v59, v59, 11, 5
    v_lshlrev_b32 v59, 2, v59
    s_waitcnt vmcnt(2)
    v_bfe_u32 v68, v42, 16, 8
    s_mov_b64 exec, s[60:61]
    v_lshlrev_b32 v68, 2, v68
    v_add_u32 v60, s83, v42
    ds_add_u32 v68, v23 offset:57344
    v_bfe_u32 v60, v60, 11, 5
    v_lshlrev_b32 v60, 2, v60
    s_waitcnt vmcnt(1)
    v_bfe_u32 v69, v46, 16, 8
    s_mov_b64 exec, s[62:63]
    v_lshlrev_b32 v69, 2, v69
    v_add_u32 v61, s83, v46
    ds_add_u32 v69, v23 offset:57344
    v_bfe_u32 v61, v61, 11, 5
    v_lshlrev_b32 v61, 2, v61
    s_waitcnt vmcnt(0)
    v_bfe_u32 v70, v50, 16, 8
    s_mov_b64 exec, s[64:65]
    v_lshlrev_b32 v70, 2, v70
    v_add_u32 v62, s83, v50
    ds_add_u32 v70, v23 offset:57344
    v_bfe_u32 v62, v62, 11, 5
    v_lshlrev_b32 v62, 2, v62
    s_mov_b64 exec, -1
    v_lshlrev_b32 v22, 2, v63
    v_cmp_gt_u32 vcc, 200, v63
    s_waitcnt lgkmcnt(0)
    s_barrier
    s_cmp_lt_u32 s3, 4
    s_cbranch_scc1 tp_main_kernel_rank
    buffer_load_dwordx2 v[24:25], v72, s[24:27], 0 offen
    buffer_load_dwordx2 v[28:29], v73, s[24:27], 0 offen
    buffer_load_dwordx2 v[32:33], v74, s[24:27], 0 offen
    buffer_load_dwordx2 v[36:37], v75, s[24:27], 0 offen
    s_barrier
    buffer_load_dwordx2 v[40:41], v76, s[24:27], 0 offen
    buffer_load_dwordx2 v[44:45], v77, s[24:27], 0 offen
    buffer_load_dwordx2 v[48:49], v78, s[24:27], 0 offen
    s_branch tp_main_kernel_nomap
tp_main_kernel_rank:
    s_and_b64 exec, exec, vcc
    ds_read_b32 v21, v22 offset:57344
    s_waitcnt lgkmcnt(0)
    v_min_u32 v21, 63, v21
    v_sub_u32 v21, 63, v21
    v_lshlrev_b32 v21, 2, v21
    ds_add_rtn_u32 v20, v21, v23 offset:60416
    s_mov_b64 exec, -1
    v_lshlrev_b32 v19, 2, v16
    s_waitcnt lgkmcnt(0)
    s_barrier
    ds_read_b32 v18, v19 offset:60416
    s_waitcnt lgkmcnt(0)
    v_mov_b32 v19, v18
    s_nop 1
    v_add_u32_dpp v19, v19, v19 row_shr:1 row_mask:0xf bank_mask:0xf bound_ctrl:0
    s_nop 1
    v_add_u32_dpp v19, v19, v19 row_shr:2 row_mask:0xf bank_mask:0xf bound_ctrl:0
    s_nop 1
    v_add_u32_dpp v19, v19, v19 row_shr:4 row_mask:0xf bank_mask:0xf bound_ctrl:0
    s_nop 1
    v_add_u32_dpp v19, v19, v19 row_shr:8 row_mask:0xf bank_mask:0xf bound_ctrl:0
    s_nop 1
    v_add_u32_dpp v19, v19, v19 row_bcast:15 row_mask:0xa bank_mask:0xf
    s_nop 1
    v_add_u32_dpp v19, v19, v19 row_bcast:31 row_mask:0xc bank_mask:0xf
    v_sub_u32 v19, v19, v18
    ds_bpermute_b32 v19, v21, v19
    s_cmp_lg_u32 s35, s36
    s_cselect_b64 s[50:51], -1, 0
    s_and_b64 exec, exec, vcc
    s_waitcnt lgkmcnt(0)
    v_add_u32 v19, v19, v20
    v_cndmask_b32 v19, v19, v63, s[50:51]
    v_lshrrev_b32 v18, 3, v19
    v_bfe_i32 v20, v19, 3, 1
    v_xor_b32 v19, v19, v20
    v_and_b32 v19, 7, v19
    v_lshl_add_u32 v20, v19, 5, v18
    ds_write_b8 v20, v63 offset:10496
    v_lshl_or_b32 v18, v19, 23, v18
    ds_write_b32 v22, v18 offset:59392
    s_mov_b64 exec, -1
tp_main_kernel_nomap:
    s_waitcnt lgkmcnt(0)
    s_barrier
    ds_read_b32 v27, v64 offset:59392
    ds_read_b32 v31, v65 offset:59392
    ds_read_b32 v35, v66 offset:59392
    ds_read_b32 v39, v67 offset:59392
    ds_read_b32 v43, v68 offset:59392
    ds_read_b32 v47, v69 offset:59392
    ds_read_b32 v51, v70 offset:59392
    s_cmp_ge_u32 s3, 4
    s_cbranch_scc1 tp_main_kernel_nopay1
    buffer_load_dwordx2 v[24:25], v72, s[24:27], 0 offen
    buffer_load_dwordx2 v[28:29], v73, s[24:27], 0 offen
    buffer_load_dwordx2 v[32:33], v74, s[24:27], 0 offen
tp_main_kernel_nopay1:
    s_waitcnt lgkmcnt(0)
    v_add_u32_sdwa v64, v56, v27 dst_sel:DWORD dst_unused:UNUSED_PAD src0_sel:DWORD src1_sel:WORD_1
    v_add_u32_sdwa v65, v57, v31 dst_sel:DWORD dst_unused:UNUSED_PAD src0_sel:DWORD src1_sel:WORD_1
    v_add_u32_sdwa v66, v58, v35 dst_sel:DWORD dst_unused:UNUSED_PAD src0_sel:DWORD src1_sel:WORD_1
    v_add_u32_sdwa v67, v59, v39 dst_sel:DWORD dst_unused:UNUSED_PAD src0_sel:DWORD src1_sel:WORD_1
    v_add_u32_sdwa v68, v60, v43 dst_sel:DWORD dst_unused:UNUSED_PAD src0_sel:DWORD src1_sel:WORD_1
    v_add_u32_sdwa v69, v61, v47 dst_sel:DWORD dst_unused:UNUSED_PAD src0_sel:DWORD src1_sel:WORD_1
    v_add_u32_sdwa v70, v62, v51 dst_sel:DWORD dst_unused:UNUSED_PAD src0_sel:DWORD src1_sel:WORD_1
    s_mov_b64 exec, s[52:53]
    ds_add_rtn_u32 v56, v64, v23 offset:56320
    s_mov_b64 exec, s[54:55]
    ds_add_rtn_u32 v57, v65, v23 offset:56320
    s_mov_b64 exec, s[56:57]
    ds_add_rtn_u32 v58, v66, v23 offset:56320
    s_mov_b64 exec, s[58:59]
    ds_add_rtn_u32 v59, v67, v23 offset:56320
    s_mov_b64 exec, s[60:61]
    ds_add_rtn_u32 v60, v68, v23 offset:56320
    s_mov_b64 exec, s[62:63]
    ds_add_rtn_u32 v61, v69, v23 offset:56320
    s_mov_b64 exec, s[64:65]
    ds_add_rtn_u32 v62, v70, v23 offset:56320
    s_mov_b64 exec, -1
    s_cbranch_scc1 tp_main_kernel_nopay2
    buffer_load_dwordx2 v[36:37], v75, s[24:27], 0 offen
    buffer_load_dwordx2 v[40:41], v76, s[24:27], 0 offen
    buffer_load_dwordx2 v[44:45], v77, s[24:27], 0 offen
    buffer_load_dwordx2 v[48:49], v78, s[24:27], 0 offen
tp_main_kernel_nopay2:
    s_waitcnt lgkmcnt(0)
    s_barrier
    ds_read_b128 v[72:75], v0 offset:56320
    buffer_load_dword v9, v8, s[4:7], s79 offen
    s_add_u32 s79, s79, 1048576
    s_waitcnt lgkmcnt(0)
    v_add_u32 v77, v72, v73
    v_add_u32 v78, v77, v74
    v_add_u32 v79, v78, v75
    v_mov_b32 v71, v79
    s_nop 1
    v_add_u32_dpp v71, v71, v71 row_shr:1 row_mask:0xf bank_mask:0xf bound_ctrl:0
    s_nop 1
    v_add_u32_dpp v71, v71, v71 row_shr:2 row_mask:0xf bank_mask:0xf bound_ctrl:0
    s_nop 1
    v_add_u32_dpp v71, v71, v71 row_shr:4 row_mask:0xf bank_mask:0xf bound_ctrl:0
    v_and_b32 v23, 7, v16
    v_cmp_eq_u32 vcc, 7, v23
    v_sub_u32 v76, 0, v71
    v_and_b32 v76, 15, v76
    v_cndmask_b32 v76, 0, v76, vcc
    v_add_u32 v79, v79, v76
    v_mov_b32 v76, v79
    s_nop 1
    v_add_u32_dpp v76, v76, v76 row_shr:1 row_mask:0xf bank_mask:0xf bound_ctrl:0
    s_nop 1
    v_add_u32_dpp v76, v76, v76 row_shr:2 row_mask:0xf bank_mask:0xf bound_ctrl:0
    s_nop 1
    v_add_u32_dpp v76, v76, v76 row_shr:4 row_mask:0xf bank_mask:0xf bound_ctrl:0
    s_nop 1
    v_add_u32_dpp v76, v76, v76 row_shr:8 row_mask:0xf bank_mask:0xf bound_ctrl:0
    s_nop 1
    v_add_u32_dpp v76, v76, v76 row_bcast:15 row_mask:0xa bank_mask:0xf
    s_nop 1
    v_add_u32_dpp v76, v76, v76 row_bcast:31 row_mask:0xc bank_mask:0xf
    v_sub_u32 v76, v76, v79
    v_add_u32 v79, v76, v78
    v_add_u32 v78, v76, v77
    v_add_u32 v77, v76, v72
    ds_write_b128 v0, v[76:79] offset:58368
    s_lshl_b32 s48, s3, 3
    s_add_u32 s49, s48, 7
    v_readlane_b32 s37, v76, s48
    v_readlane_b32 s50, v71, s49
    ds_read_b32 v64, v64 offset:58368
    ds_read_b32 v65, v65 offset:58368
    ds_read_b32 v66, v66 offset:58368
    ds_read_b32 v67, v67 offset:58368
    ds_read_b32 v68, v68 offset:58368
    ds_read_b32 v69, v69 offset:58368
    ds_read_b32 v70, v70 offset:58368
    s_add_u32 s38, s50, 15
    s_lshr_b32 s38, s38, 4
    s_lshl_b32 s51, s38, 4
    s_sub_u32 s82, s51, s50
    s_cmp_ge_u32 s82, 8
    s_cselect_b32 s82, 0, -2
    s_cmp_eq_u32 s3, 7
    s_cselect_b32 s81, 16, 0
    s_add_u32 s51, s51, s81
    s_mov_b32 s81, 0
    v_add_u32 v23, s50, v16
    v_cmp_gt_u32 vcc, s51, v23
    v_add_u32 v23, s37, v23
    v_mov_b32 v18, 0
    v_mov_b32 v19, 0xffff0000
    v_mov_b32 v20, 0x1fffffe0
    v_lshlrev_b32 v21, 3, v23
    v_lshlrev_b32 v22, 2, v23
    s_and_b64 exec, exec, vcc
    ds_write_b64 v21, v[18:19] offset:10752
    ds_write_b32 v22, v20 offset:40512
    s_mov_b64 exec, -1
    s_waitcnt lgkmcnt(0)
    s_mov_b32 s48, 0x0c070302
    s_mov_b32 s49, 0x05040100
    s_waitcnt vmcnt(1)
    s_mov_b64 exec, s[52:53]
    v_perm_b32 v20, v26, v25, s48
    v_perm_b32 v25, v26, v25, s49
    v_lshlrev_b32 v20, 5, v20
    v_add_lshl_u32 v21, v64, v56, 3
    v_add_lshl_u32 v22, v64, v56, 2
    v_and_or_b32 v26, v27, 31, v20
    ds_write_b64 v21, v[24:25] offset:10752
    ds_write_b32 v22, v26 offset:40512
    s_mov_b64 exec, s[54:55]
    v_perm_b32 v20, v30, v29, s48
    v_perm_b32 v29, v30, v29, s49
    v_lshlrev_b32 v20, 5, v20
    v_add_lshl_u32 v21, v65, v57, 3
    v_add_lshl_u32 v22, v65, v57, 2
    v_and_or_b32 v30, v31, 31, v20
    ds_write_b64 v21, v[28:29] offset:10752
    ds_write_b32 v22, v30 offset:40512
    s_mov_b64 exec, s[56:57]
    v_perm_b32 v20, v34, v33, s48
    v_perm_b32 v33, v34, v33, s49
    v_lshlrev_b32 v20, 5, v20
    v_add_lshl_u32 v21, v66, v58, 3
    v_add_lshl_u32 v22, v66, v58, 2
    v_and_or_b32 v34, v35, 31, v20
    ds_write_b64 v21, v[32:33] offset:10752
    ds_write_b32 v22, v34 offset:40512
    s_mov_b64 exec, s[58:59]
    v_perm_b32 v20, v38, v37, s48
    v_perm_b32 v37, v38, v37, s49
    v_lshlrev_b32 v20, 5, v20
    v_add_lshl_u32 v21, v67, v59, 3
    v_add_lshl_u32 v22, v67, v59, 2
    v_and_or_b32 v38, v39, 31, v20
    ds_write_b64 v21, v[36:37] offset:10752
    ds_write_b32 v22, v38 offset:40512
    s_mov_b64 exec, s[60:61]
    v_perm_b32 v20, v42, v41, s48
    v_perm_b32 v41, v42, v41, s49
    v_lshlrev_b32 v20, 5, v20
    v_add_lshl_u32 v21, v68, v60, 3
    v_add_lshl_u32 v22, v68, v60, 2
    v_and_or_b32 v42, v43, 31, v20
    ds_write_b64 v21, v[40:41] offset:10752
    ds_write_b32 v22, v42 offset:40512
    s_mov_b64 exec, s[62:63]
    v_perm_b32 v20, v46, v45, s48
    v_perm_b32 v45, v46, v45, s49
    v_lshlrev_b32 v20, 5, v20
    v_add_lshl_u32 v21, v69, v61, 3
    v_add_lshl_u32 v22, v69, v61, 2
    v_and_or_b32 v46, v47, 31, v20
    ds_write_b64 v21, v[44:45] offset:10752
    ds_write_b32 v22, v46 offset:40512
    s_mov_b64 exec, s[64:65]
    v_perm_b32 v20, v50, v49, s48
    v_perm_b32 v49, v50, v49, s49
    v_lshlrev_b32 v20, 5, v20
    v_add_lshl_u32 v21, v70, v62, 3
    v_add_lshl_u32 v22, v70, v62, 2
    v_and_or_b32 v50, v51, 31, v20
    ds_write_b64 v21, v[48:49] offset:10752
    ds_write_b32 v22, v50 offset:40512
    s_mov_b64 exec, -1
    v_add_lshl_u32 v2, v2, s37, 3
    v_add_u32 v2, 10756, v2
    v_add_lshl_u32 v3, v3, s37, 3
    v_add_lshl_u32 v4, v4, s37, 2
    v_mov_b32 v7, v12
    s_movk_i32 s78, 512
    s_lshl_b32 s48, s2, 7
    s_add_u32 s48, s48, s3
    s_add_u32 s70, s37, 63
    s_lshr_b32 s70, s70, 6
    s_add_u32 s70, s70, s48
    s_lshl_b32 s70, s70, 6
    s_add_u32 s92, s70, 16
    s_lshl_b32 s49, s38, 4
    s_max_u32 s48, s49, 1
    s_sub_u32 s48, s48, 1
    s_and_b32 s48, s48, 0xff00
    s_mov_b32 s50, 0x0c0c0400
    s_mov_b32 s51, 0x04000c0c
    v_lshrrev_b32 v15, 2, v0
    s_lshr_b32 s71, s2, 3
    s_lshl_b32 s71, s71, 3
    s_add_u32 s71, s71, s3
    s_mul_i32 s71, s71, 12800
    s_lshl_b32 s79, s83, 9
    s_sub_u32 s79, 33554432, s79
    s_add_u32 s79, s79, s71
    s_mul_i32 s71, s3, 2
    s_add_u32 s71, s71, 2
    s_sub_u32 s39, s38, 1
    s_waitcnt lgkmcnt(0)
    s_barrier
    ds_read_b32 v40, v4 offset:40512
    ds_read_u16 v42, v2 offset:2
    ds_read_u16 v43, v2 offset:66
    ds_read_b64 v[48:49], v3 offset:10752
    ds_read2_b32 v[12:13], v2 offset0:32 offset1:48
    ds_read_b128 v[64:67], v0 offset:6144
    ds_read_b128 v[68:71], v0 offset:7168
    s_waitcnt lgkmcnt(4)
    v_lshl_or_b32 v42, v42, 9, v14
    v_lshl_or_b32 v43, v43, 9, v14
    s_cmp_ge_i32 s39, 0
    s_cselect_b32 s80, s68, s69
    s_add_u32 m0, s33, 12416
    v_bfi_b32 v40, 31, v0, v40
    buffer_load_dwordx4 v40, s[8:11], s80 offen lds
    s_add_u32 m0, s33, -128
    s_nop 0
    buffer_load_dwordx4 v42, s[4:7], s80 offen offset:128 lds
    s_add_u32 m0, s33, 3904
    s_nop 0
    buffer_load_dwordx4 v42, s[4:7], s80 offen offset:256 lds
    s_add_u32 m0, s33, 7936
    s_nop 0
    buffer_load_dwordx4 v42, s[4:7], s80 offen offset:384 lds
tp_main_kernel_idcopy:
    v_add_u32 v60, s48, v15
    v_add_lshl_u32 v61, v60, s37, 2
    v_cmp_gt_u32 vcc, s49, v60
    ds_read_b128 v[56:59], v61 offset:40512
    v_bfrev_b32 v61, 1
    v_cndmask_b32 v60, v61, v60, vcc
    s_waitcnt lgkmcnt(0)
    v_perm_b32 v56, v57, v56, s50
    v_perm_b32 v58, v59, v58, s51
    v_or_b32 v56, v56, v58
    v_and_b32 v56, 0x1f1f1f1f, v56
    s_sub_u32 s48, s48, 256
    buffer_store_dword v56, v60, s[88:91], s70 offen
    s_cbranch_scc0 tp_main_kernel_idcopy
    v_readlane_b32 s44, v56, 0
    v_readlane_b32 s45, v56, 1
    v_readlane_b32 s46, v56, 2
    v_readlane_b32 s47, v56, 3
    v_mov_b64 v[180:181], 0
    v_mov_b64 v[182:183], 0
    v_mov_b64 v[184:185], 0
    v_mov_b64 v[186:187], 0
    v_mov_b64 v[188:189], 0
    v_mov_b64 v[190:191], 0
    v_mov_b64 v[192:193], 0
    v_mov_b64 v[194:195], 0
    v_mov_b64 v[196:197], 0
    v_mov_b64 v[198:199], 0
    v_mov_b64 v[200:201], 0
    v_mov_b64 v[202:203], 0
    v_mov_b64 v[204:205], 0
    v_mov_b64 v[206:207], 0
    v_mov_b64 v[208:209], 0
    v_mov_b64 v[210:211], 0
    v_mov_b64 v[212:213], 0
    v_mov_b64 v[214:215], 0
    v_mov_b64 v[216:217], 0
    v_mov_b64 v[218:219], 0
    v_mov_b64 v[220:221], 0
    v_mov_b64 v[222:223], 0
    v_mov_b64 v[224:225], 0
    v_mov_b64 v[226:227], 0
    v_mov_b64 v[228:229], 0
    v_mov_b64 v[230:231], 0
    v_mov_b64 v[232:233], 0
    v_mov_b64 v[234:235], 0
    v_mov_b64 v[236:237], 0
    v_mov_b64 v[238:239], 0
    v_mov_b64 v[240:241], 0
    v_mov_b64 v[242:243], 0
    v_mov_b64 v[244:245], 0
    v_mov_b64 v[246:247], 0
    v_mov_b64 v[248:249], 0
    v_mov_b64 v[250:251], 0
    v_mov_b64 v[252:253], 0
    v_mov_b64 v[254:255], 0
    s_add_u32 m0, s33, 896
    s_nop 0
    buffer_load_dwordx4 v43, s[4:7], s80 offen offset:128 lds
    s_add_u32 m0, s33, 4928
    s_nop 0
    buffer_load_dwordx4 v43, s[4:7], s80 offen offset:256 lds
    s_add_u32 m0, s33, 8960
    s_nop 0
    buffer_load_dwordx4 v43, s[4:7], s80 offen offset:384 lds
    s_cmp_eq_u32 s38, 0
    s_cbranch_scc1 tp_main_kernel_b_done
    s_waitcnt lgkmcnt(0)
    s_lshl_b32 s49, s38, 4
    s_add_u32 s49, s49, s70
    s_mov_b32 s48, s70
    s_waitcnt vmcnt(3)
    s_cmp_eq_u32 s34, 0
    s_cbranch_scc1 tp_main_kernel_idfresh
tp_main_kernel_idwarm:
    s_buffer_load_dword s50, s[88:91], s48 glc
    s_add_u32 s48, s48, 64
    s_cmp_le_u32 s48, s49
    s_cbranch_scc1 tp_main_kernel_idwarm
    s_waitcnt lgkmcnt(0)
tp_main_kernel_idfresh:
    ds_read_b128 v[24:27], v5 offset:0
    ds_read_b128 v[72:75], v0 offset:8192
    ds_read_b128 v[28:31], v80 offset:0
tp_main_kernel_b_loop:
    s_cmp_le_i32 s39, s71
    s_cbranch_scc1 tp_main_kernel_b_ahead
tp_main_kernel_b_back:
    s_waitcnt lgkmcnt(2)
    v_mfma_f32_32x32x16_bf16 v[32:47], v[24:27], v[64:67], 0
    ds_read_b128 v[76:79], v0 offset:9216
    ds_read_b128 v[20:23], v0 offset:2048
    ds_read_b128 v[16:19], v0 offset:3072
    v_mad_u32_u16 v12, v12, s78, v14 op_sel:[1,0,0,0]
    s_cmp_ge_i32 s39, 1
    s_cselect_b32 s80, s68, s69
    s_waitcnt lgkmcnt(3)
    v_mfma_f32_32x32x16_bf16 v[32:47], v[28:31], v[68:71], v[32:47]
    v_perm_b32 v8, v49, v48, v10
    v_perm_b32 v9, v49, v48, v11
    s_add_u32 m0, s33, 1920
    v_mfma_f32_32x32x16_bf16 v[48:63], v[24:27], v[72:75], 0
    buffer_load_dwordx4 v12, s[4:7], s80 offen offset:128 lds
    s_add_u32 m0, s33, 5952
    s_waitcnt lgkmcnt(0)
    buffer_load_dwordx4 v12, s[4:7], s80 offen offset:256 lds
    s_add_u32 m0, s33, 9984
    v_mad_u32_u16 v13, v13, s78, v14 op_sel:[1,0,0,0]
    buffer_load_dwordx4 v12, s[4:7], s80 offen offset:384 lds
    s_add_u32 m0, s33, 2944
    v_mfma_f32_32x32x16_bf16 v[48:63], v[28:31], v[76:79], v[48:63]
    buffer_load_dwordx4 v13, s[4:7], s80 offen offset:128 lds
    s_add_u32 m0, s33, 6976
    s_mul_i32 s40, s44, 7
    buffer_load_dwordx4 v13, s[4:7], s80 offen offset:256 lds
    s_add_u32 m0, s33, 11008
    s_mul_i32 s41, s45, 7
    buffer_load_dwordx4 v13, s[4:7], s80 offen offset:384 lds
    v_mfma_f32_32x32x16_bf16 v[64:79], v[24:27], v[20:23], 0
    s_waitcnt vmcnt(9)
    ds_read_b64_tr_b16 v[20:21], v1 offset:0
    ds_read_b64_tr_b16 v[22:23], v6 offset:0
    ds_read_b64_tr_b16 v[24:25], v1 offset:128
    ds_read_b64_tr_b16 v[26:27], v6 offset:128
    v_xor_b32 v8, v8, v7
    v_mfma_f32_32x32x16_bf16 v[64:79], v[28:31], v[16:19], v[64:79]
    ds_read2_b32 v[12:13], v2 offset0:64 offset1:80
    s_mul_i32 s42, s46, 7
    s_mul_i32 s43, s47, 7
    s_buffer_load_dwordx4 s[44:47], s[88:91], s92
    s_add_u32 s92, s92, 16
    s_setprio 3
    s_waitcnt lgkmcnt(3)
    v_mfma_f32_4x4x4_16b_bf16 v[16:19], v[8:9], v[20:21], 0 cbsz:4 abid:0
    s_set_gpr_idx_on s40, 0x8
    ds_read_b64_tr_b16 v[28:29], v1 offset:256
    ds_read_b64_tr_b16 v[30:31], v6 offset:256
    v_fmac_f32 v85, v22, v32
    v_fmac_f32 v86, v23, v32
    v_fmac_f32 v87, v21, v32
    v_fmac_f32 v81, v16, v48
    v_fmac_f32 v82, v17, v48
    v_fmac_f32 v83, v18, v48
    v_fmac_f32 v84, v19, v64
    s_bfe_u32 m0, s41, 0x80000
    s_waitcnt lgkmcnt(3)
    v_mfma_f32_4x4x4_16b_bf16 v[16:19], v[8:9], v[24:25], 0 cbsz:4 abid:1
    s_set_gpr_idx_mode 0x8
    ds_read_b64_tr_b16 v[20:21], v1 offset:384
    ds_read_b64_tr_b16 v[22:23], v6 offset:384
    v_fmac_f32 v85, v26, v33
    v_fmac_f32 v86, v27, v33
    v_fmac_f32 v87, v25, v33
    v_fmac_f32 v81, v16, v49
    v_fmac_f32 v82, v17, v49
    v_fmac_f32 v83, v18, v49
    v_fmac_f32 v84, v19, v65
    s_bfe_u32 m0, s40, 0x80008
    s_waitcnt lgkmcnt(2)
    v_mfma_f32_4x4x4_16b_bf16 v[16:19], v[8:9], v[28:29], 0 cbsz:4 abid:2
    s_set_gpr_idx_mode 0x8
    ds_read_b64_tr_b16 v[24:25], v1 offset:512
    ds_read_b64_tr_b16 v[26:27], v6 offset:512
    v_fmac_f32 v85, v30, v34
    v_fmac_f32 v86, v31, v34
    v_fmac_f32 v87, v29, v34
    v_fmac_f32 v81, v16, v50
    v_fmac_f32 v82, v17, v50
    v_fmac_f32 v83, v18, v50
    v_fmac_f32 v84, v19, v66
    s_bfe_u32 m0, s41, 0x80008
    s_waitcnt lgkmcnt(2)
    v_mfma_f32_4x4x4_16b_bf16 v[16:19], v[8:9], v[20:21], 0 cbsz:4 abid:3
    s_set_gpr_idx_mode 0x8
    ds_read_b64_tr_b16 v[28:29], v1 offset:640
    ds_read_b64_tr_b16 v[30:31], v6 offset:640
    v_fmac_f32 v85, v22, v35
    v_fmac_f32 v86, v23, v35
    v_fmac_f32 v87, v21, v35
    v_fmac_f32 v81, v16, v51
    v_fmac_f32 v82, v17, v51
    v_fmac_f32 v83, v18, v51
    v_fmac_f32 v84, v19, v67
    s_bfe_u32 m0, s40, 0x80010
    s_waitcnt lgkmcnt(2)
    v_mfma_f32_4x4x4_16b_bf16 v[16:19], v[8:9], v[24:25], 0 cbsz:4 abid:4
    s_set_gpr_idx_mode 0x8
    ds_read_b64 v[48:49], v3 offset:10880
    ds_read_b64_tr_b16 v[20:21], v1 offset:768
    ds_read_b64_tr_b16 v[22:23], v6 offset:768
    v_fmac_f32 v85, v26, v36
    v_fmac_f32 v86, v27, v36
    v_fmac_f32 v87, v25, v36
    v_fmac_f32 v81, v16, v52
    v_fmac_f32 v82, v17, v52
    v_fmac_f32 v83, v18, v52
    v_fmac_f32 v84, v19, v68
    s_bfe_u32 m0, s41, 0x80010
    s_waitcnt lgkmcnt(3)
    v_mfma_f32_4x4x4_16b_bf16 v[16:19], v[8:9], v[28:29], 0 cbsz:4 abid:5
    s_set_gpr_idx_mode 0x8
    ds_read_b64_tr_b16 v[24:25], v1 offset:896
    ds_read_b64_tr_b16 v[26:27], v6 offset:896
    v_fmac_f32 v85, v30, v37
    v_fmac_f32 v86, v31, v37
    v_fmac_f32 v87, v29, v37
    v_fmac_f32 v81, v16, v53
    v_fmac_f32 v82, v17, v53
    v_fmac_f32 v83, v18, v53
    v_fmac_f32 v84, v19, v69
    s_lshr_b32 m0, s40, 24
    s_waitcnt vmcnt(6) lgkmcnt(2)
    v_mfma_f32_4x4x4_16b_bf16 v[16:19], v[8:9], v[20:21], 0 cbsz:4 abid:6
    s_set_gpr_idx_mode 0x8
    ds_read_b32 v51, v4 offset:40640
    ds_read_b64_tr_b16 v[28:29], v1 offset:1024
    ds_read_b64_tr_b16 v[30:31], v6 offset:1024
    v_fmac_f32 v85, v22, v38
    v_fmac_f32 v86, v23, v38
    v_fmac_f32 v87, v21, v38
    v_fmac_f32 v81, v16, v54
    v_fmac_f32 v82, v17, v54
    v_fmac_f32 v83, v18, v54
    v_fmac_f32 v84, v19, v70
    s_lshr_b32 m0, s41, 24
    s_waitcnt lgkmcnt(3)
    v_mfma_f32_4x4x4_16b_bf16 v[16:19], v[8:9], v[24:25], 0 cbsz:4 abid:7
    s_set_gpr_idx_mode 0x8
    ds_read_b64_tr_b16 v[20:21], v1 offset:1152
    ds_read_b64_tr_b16 v[22:23], v6 offset:1152
    v_fmac_f32 v85, v26, v39
    v_fmac_f32 v86, v27, v39
    v_fmac_f32 v87, v25, v39
    v_fmac_f32 v81, v16, v55
    v_fmac_f32 v82, v17, v55
    v_fmac_f32 v83, v18, v55
    v_fmac_f32 v84, v19, v71
    s_bfe_u32 m0, s42, 0x80000
    s_cmp_eq_u32 s39, s82
    s_cbranch_scc1 tp_main_kernel_b_done
    s_waitcnt lgkmcnt(2)
    v_mfma_f32_4x4x4_16b_bf16 v[16:19], v[8:9], v[28:29], 0 cbsz:4 abid:8
    s_set_gpr_idx_mode 0x8
    ds_read_b64_tr_b16 v[24:25], v1 offset:1280
    ds_read_b64_tr_b16 v[26:27], v6 offset:1280
    v_fmac_f32 v85, v30, v40
    v_fmac_f32 v86, v31, v40
    v_fmac_f32 v87, v29, v40
    v_fmac_f32 v81, v16, v56
    v_fmac_f32 v82, v17, v56
    v_fmac_f32 v83, v18, v56
    v_fmac_f32 v84, v19, v72
    s_bfe_u32 m0, s43, 0x80000
    s_waitcnt lgkmcnt(2)
    v_mfma_f32_4x4x4_16b_bf16 v[16:19], v[8:9], v[20:21], 0 cbsz:4 abid:9
    s_set_gpr_idx_mode 0x8
    ds_read_b64_tr_b16 v[28:29], v1 offset:1408
    ds_read_b64_tr_b16 v[30:31], v6 offset:1408
    v_fmac_f32 v85, v22, v41
    v_fmac_f32 v86, v23, v41
    v_fmac_f32 v87, v21, v41
    v_fmac_f32 v81, v16, v57
    v_fmac_f32 v82, v17, v57
    v_fmac_f32 v83, v18, v57
    v_fmac_f32 v84, v19, v73
    s_bfe_u32 m0, s42, 0x80008
    s_waitcnt lgkmcnt(2)
    v_mfma_f32_4x4x4_16b_bf16 v[16:19], v[8:9], v[24:25], 0 cbsz:4 abid:10
    s_set_gpr_idx_mode 0x8
    ds_read_b64_tr_b16 v[20:21], v1 offset:1536
    ds_read_b64_tr_b16 v[22:23], v6 offset:1536
    v_fmac_f32 v85, v26, v42
    v_fmac_f32 v86, v27, v42
    v_fmac_f32 v87, v25, v42
    v_fmac_f32 v81, v16, v58
    v_fmac_f32 v82, v17, v58
    v_fmac_f32 v83, v18, v58
    v_fmac_f32 v84, v19, v74
    s_bfe_u32 m0, s43, 0x80008
    s_waitcnt lgkmcnt(2)
    v_mfma_f32_4x4x4_16b_bf16 v[16:19], v[8:9], v[28:29], 0 cbsz:4 abid:11
    s_set_gpr_idx_mode 0x8
    ds_read_b64_tr_b16 v[24:25], v1 offset:1664
    ds_read_b64_tr_b16 v[26:27], v6 offset:1664
    v_fmac_f32 v85, v30, v43
    v_fmac_f32 v86, v31, v43
    v_fmac_f32 v87, v29, v43
    v_fmac_f32 v81, v16, v59
    v_fmac_f32 v82, v17, v59
    v_fmac_f32 v83, v18, v59
    v_fmac_f32 v84, v19, v75
    s_bfe_u32 m0, s42, 0x80010
    s_waitcnt lgkmcnt(2)
    v_mfma_f32_4x4x4_16b_bf16 v[16:19], v[8:9], v[20:21], 0 cbsz:4 abid:12
    s_set_gpr_idx_mode 0x8
    ds_read_b128 v[64:67], v0 offset:6144
    ds_read_b128 v[68:71], v0 offset:7168
    ds_read_b64_tr_b16 v[28:29], v1 offset:1792
    ds_read_b64_tr_b16 v[30:31], v6 offset:1792
    v_fmac_f32 v85, v22, v44
    v_fmac_f32 v86, v23, v44
    v_fmac_f32 v87, v21, v44
    v_fmac_f32 v81, v16, v60
    v_fmac_f32 v82, v17, v60
    v_fmac_f32 v83, v18, v60
    v_fmac_f32 v84, v19, v76
    s_bfe_u32 m0, s43, 0x80010
    s_waitcnt lgkmcnt(4)
    v_mfma_f32_4x4x4_16b_bf16 v[16:19], v[8:9], v[24:25], 0 cbsz:4 abid:13
    s_set_gpr_idx_mode 0x8
    ds_read_b64_tr_b16 v[20:21], v1 offset:1920
    ds_read_b64_tr_b16 v[22:23], v6 offset:1920
    v_fmac_f32 v85, v26, v45
    v_fmac_f32 v86, v27, v45
    v_fmac_f32 v87, v25, v45
    v_fmac_f32 v81, v16, v61
    v_fmac_f32 v82, v17, v61
    v_fmac_f32 v83, v18, v61
    v_fmac_f32 v84, v19, v77
    s_lshr_b32 m0, s42, 24
    s_waitcnt lgkmcnt(2)
    v_mfma_f32_4x4x4_16b_bf16 v[16:19], v[8:9], v[28:29], 0 cbsz:4 abid:14
    s_set_gpr_idx_mode 0x8
    ds_read_b128 v[24:27], v5 offset:512
    ds_read_b128 v[72:75], v0 offset:8192
    v_fmac_f32 v85, v30, v46
    v_fmac_f32 v86, v31, v46
    v_fmac_f32 v87, v29, v46
    v_fmac_f32 v81, v16, v62
    v_fmac_f32 v82, v17, v62
    v_fmac_f32 v83, v18, v62
    v_fmac_f32 v84, v19, v78
    s_lshr_b32 m0, s43, 24
    s_waitcnt lgkmcnt(2)
    v_mfma_f32_4x4x4_16b_bf16 v[16:19], v[8:9], v[20:21], 0 cbsz:4 abid:15
    s_set_gpr_idx_mode 0x8
    ds_read_b128 v[28:31], v80 offset:512
    v_fmac_f32 v85, v22, v47
    v_fmac_f32 v86, v23, v47
    v_fmac_f32 v87, v21, v47
    v_fmac_f32 v81, v16, v63
    v_fmac_f32 v82, v17, v63
    v_fmac_f32 v83, v18, v63
    v_fmac_f32 v84, v19, v79
    s_set_gpr_idx_off
    s_sub_u32 s39, s39, 1
    s_cbranch_scc1 tp_main_kernel_b_done
    s_waitcnt lgkmcnt(2)
    v_mfma_f32_32x32x16_bf16 v[32:47], v[24:27], v[64:67], 0
    ds_read_b128 v[76:79], v0 offset:9216
    ds_read_b128 v[20:23], v0 offset:2048
    ds_read_b128 v[16:19], v0 offset:3072
    v_mad_u32_u16 v12, v12, s78, v14 op_sel:[1,0,0,0]
    s_cmp_ge_i32 s39, 1
    s_cselect_b32 s80, s68, s69
    s_waitcnt lgkmcnt(3)
    v_mfma_f32_32x32x16_bf16 v[32:47], v[28:31], v[68:71], v[32:47]
    s_add_u32 m0, s33, 12416
    v_bfi_b32 v51, 31, v0, v51
    buffer_load_dwordx4 v51, s[8:11], s80 offen lds
    v_perm_b32 v8, v49, v48, v10
    v_perm_b32 v9, v49, v48, v11
    s_add_u32 m0, s33, -128
    v_mfma_f32_32x32x16_bf16 v[48:63], v[24:27], v[72:75], 0
    buffer_load_dwordx4 v12, s[4:7], s80 offen offset:128 lds
    s_add_u32 m0, s33, 3904
    s_waitcnt lgkmcnt(0)
    buffer_load_dwordx4 v12, s[4:7], s80 offen offset:256 lds
    s_add_u32 m0, s33, 7936
    v_mad_u32_u16 v13, v13, s78, v14 op_sel:[1,0,0,0]
    buffer_load_dwordx4 v12, s[4:7], s80 offen offset:384 lds
    s_add_u32 m0, s33, 896
    v_mfma_f32_32x32x16_bf16 v[48:63], v[28:31], v[76:79], v[48:63]
    buffer_load_dwordx4 v13, s[4:7], s80 offen offset:128 lds
    s_add_u32 m0, s33, 4928
    s_mul_i32 s40, s44, 7
    buffer_load_dwordx4 v13, s[4:7], s80 offen offset:256 lds
    s_add_u32 m0, s33, 8960
    s_mul_i32 s41, s45, 7
    buffer_load_dwordx4 v13, s[4:7], s80 offen offset:384 lds
    v_mfma_f32_32x32x16_bf16 v[64:79], v[24:27], v[20:23], 0
    s_waitcnt vmcnt(10)
    ds_read_b64_tr_b16 v[20:21], v1 offset:2048
    ds_read_b64_tr_b16 v[22:23], v6 offset:2048
    ds_read_b64_tr_b16 v[24:25], v1 offset:2176
    ds_read_b64_tr_b16 v[26:27], v6 offset:2176
    v_xor_b32 v8, v8, v7
    v_mfma_f32_32x32x16_bf16 v[64:79], v[28:31], v[16:19], v[64:79]
    ds_read2_b32 v[12:13], v2 offset0:96 offset1:112
    s_mul_i32 s42, s46, 7
    s_mul_i32 s43, s47, 7
    s_buffer_load_dwordx4 s[44:47], s[88:91], s92
    s_add_u32 s92, s92, 16
    s_waitcnt lgkmcnt(3)
    v_mfma_f32_4x4x4_16b_bf16 v[16:19], v[8:9], v[20:21], 0 cbsz:4 abid:0
    s_set_gpr_idx_on s40, 0x8
    ds_read_b64_tr_b16 v[28:29], v1 offset:2304
    ds_read_b64_tr_b16 v[30:31], v6 offset:2304
    v_fmac_f32 v85, v22, v32
    v_fmac_f32 v86, v23, v32
    v_fmac_f32 v87, v21, v32
    v_fmac_f32 v81, v16, v48
    v_fmac_f32 v82, v17, v48
    v_fmac_f32 v83, v18, v48
    v_fmac_f32 v84, v19, v64
    s_bfe_u32 m0, s41, 0x80000
    s_waitcnt lgkmcnt(3)
    v_mfma_f32_4x4x4_16b_bf16 v[16:19], v[8:9], v[24:25], 0 cbsz:4 abid:1
    s_set_gpr_idx_mode 0x8
    ds_read_b64_tr_b16 v[20:21], v1 offset:2432
    ds_read_b64_tr_b16 v[22:23], v6 offset:2432
    v_fmac_f32 v85, v26, v33
    v_fmac_f32 v86, v27, v33
    v_fmac_f32 v87, v25, v33
    v_fmac_f32 v81, v16, v49
    v_fmac_f32 v82, v17, v49
    v_fmac_f32 v83, v18, v49
    v_fmac_f32 v84, v19, v65
    s_bfe_u32 m0, s40, 0x80008
    s_waitcnt lgkmcnt(2)
    v_mfma_f32_4x4x4_16b_bf16 v[16:19], v[8:9], v[28:29], 0 cbsz:4 abid:2
    s_set_gpr_idx_mode 0x8
    ds_read_b64_tr_b16 v[24:25], v1 offset:2560
    ds_read_b64_tr_b16 v[26:27], v6 offset:2560
    v_fmac_f32 v85, v30, v34
    v_fmac_f32 v86, v31, v34
    v_fmac_f32 v87, v29, v34
    v_fmac_f32 v81, v16, v50
    v_fmac_f32 v82, v17, v50
    v_fmac_f32 v83, v18, v50
    v_fmac_f32 v84, v19, v66
    s_bfe_u32 m0, s41, 0x80008
    s_waitcnt lgkmcnt(2)
    v_mfma_f32_4x4x4_16b_bf16 v[16:19], v[8:9], v[20:21], 0 cbsz:4 abid:3
    s_set_gpr_idx_mode 0x8
    ds_read_b64_tr_b16 v[28:29], v1 offset:2688
    ds_read_b64_tr_b16 v[30:31], v6 offset:2688
    v_fmac_f32 v85, v22, v35
    v_fmac_f32 v86, v23, v35
    v_fmac_f32 v87, v21, v35
    v_fmac_f32 v81, v16, v51
    v_fmac_f32 v82, v17, v51
    v_fmac_f32 v83, v18, v51
    v_fmac_f32 v84, v19, v67
    s_bfe_u32 m0, s40, 0x80010
    s_waitcnt lgkmcnt(2)
    v_mfma_f32_4x4x4_16b_bf16 v[16:19], v[8:9], v[24:25], 0 cbsz:4 abid:4
    s_set_gpr_idx_mode 0x8
    ds_read_b64 v[48:49], v3 offset:11008
    ds_read_b64_tr_b16 v[20:21], v1 offset:2816
    ds_read_b64_tr_b16 v[22:23], v6 offset:2816
    v_fmac_f32 v85, v26, v36
    v_fmac_f32 v86, v27, v36
    v_fmac_f32 v87, v25, v36
    v_fmac_f32 v81, v16, v52
    v_fmac_f32 v82, v17, v52
    v_fmac_f32 v83, v18, v52
    v_fmac_f32 v84, v19, v68
    s_bfe_u32 m0, s41, 0x80010
    s_waitcnt lgkmcnt(3)
    v_mfma_f32_4x4x4_16b_bf16 v[16:19], v[8:9], v[28:29], 0 cbsz:4 abid:5
    s_set_gpr_idx_mode 0x8
    ds_read_b64_tr_b16 v[24:25], v1 offset:2944
    ds_read_b64_tr_b16 v[26:27], v6 offset:2944
    v_fmac_f32 v85, v30, v37
    v_fmac_f32 v86, v31, v37
    v_fmac_f32 v87, v29, v37
    v_fmac_f32 v81, v16, v53
    v_fmac_f32 v82, v17, v53
    v_fmac_f32 v83, v18, v53
    v_fmac_f32 v84, v19, v69
    s_lshr_b32 m0, s40, 24
    s_setprio 2
    s_cmp_lt_u32 s3, 4
    s_cbranch_scc1 1
    s_setprio 3
    s_waitcnt vmcnt(7) lgkmcnt(2)
    v_mfma_f32_4x4x4_16b_bf16 v[16:19], v[8:9], v[20:21], 0 cbsz:4 abid:6
    s_set_gpr_idx_mode 0x8
    ds_read_b64_tr_b16 v[28:29], v1 offset:3072
    ds_read_b64_tr_b16 v[30:31], v6 offset:3072
    v_fmac_f32 v85, v22, v38
    v_fmac_f32 v86, v23, v38
    v_fmac_f32 v87, v21, v38
    v_fmac_f32 v81, v16, v54
    v_fmac_f32 v82, v17, v54
    v_fmac_f32 v83, v18, v54
    v_fmac_f32 v84, v19, v70
    s_lshr_b32 m0, s41, 24
    s_waitcnt lgkmcnt(2)
    v_mfma_f32_4x4x4_16b_bf16 v[16:19], v[8:9], v[24:25], 0 cbsz:4 abid:7
    s_set_gpr_idx_mode 0x8
    ds_read_b64_tr_b16 v[20:21], v1 offset:3200
    ds_read_b64_tr_b16 v[22:23], v6 offset:3200
    v_fmac_f32 v85, v26, v39
    v_fmac_f32 v86, v27, v39
    v_fmac_f32 v87, v25, v39
    v_fmac_f32 v81, v16, v55
    v_fmac_f32 v82, v17, v55
    v_fmac_f32 v83, v18, v55
    v_fmac_f32 v84, v19, v71
    s_bfe_u32 m0, s42, 0x80000
    s_cmp_eq_u32 s39, s82
    s_cbranch_scc1 tp_main_kernel_b_done
    s_waitcnt lgkmcnt(2)
    v_mfma_f32_4x4x4_16b_bf16 v[16:19], v[8:9], v[28:29], 0 cbsz:4 abid:8
    s_set_gpr_idx_mode 0x8
    ds_read_b64_tr_b16 v[24:25], v1 offset:3328
    ds_read_b64_tr_b16 v[26:27], v6 offset:3328
    v_fmac_f32 v85, v30, v40
    v_fmac_f32 v86, v31, v40
    v_fmac_f32 v87, v29, v40
    v_fmac_f32 v81, v16, v56
    v_fmac_f32 v82, v17, v56
    v_fmac_f32 v83, v18, v56
    v_fmac_f32 v84, v19, v72
    s_bfe_u32 m0, s43, 0x80000
    s_waitcnt lgkmcnt(2)
    v_mfma_f32_4x4x4_16b_bf16 v[16:19], v[8:9], v[20:21], 0 cbsz:4 abid:9
    s_set_gpr_idx_mode 0x8
    ds_read_b64_tr_b16 v[28:29], v1 offset:3456
    ds_read_b64_tr_b16 v[30:31], v6 offset:3456
    v_fmac_f32 v85, v22, v41
    v_fmac_f32 v86, v23, v41
    v_fmac_f32 v87, v21, v41
    v_fmac_f32 v81, v16, v57
    v_fmac_f32 v82, v17, v57
    v_fmac_f32 v83, v18, v57
    v_fmac_f32 v84, v19, v73
    s_bfe_u32 m0, s42, 0x80008
    s_waitcnt lgkmcnt(2)
    v_mfma_f32_4x4x4_16b_bf16 v[16:19], v[8:9], v[24:25], 0 cbsz:4 abid:10
    s_set_gpr_idx_mode 0x8
    ds_read_b64_tr_b16 v[20:21], v1 offset:3584
    ds_read_b64_tr_b16 v[22:23], v6 offset:3584
    v_fmac_f32 v85, v26, v42
    v_fmac_f32 v86, v27, v42
    v_fmac_f32 v87, v25, v42
    v_fmac_f32 v81, v16, v58
    v_fmac_f32 v82, v17, v58
    v_fmac_f32 v83, v18, v58
    v_fmac_f32 v84, v19, v74
    s_bfe_u32 m0, s43, 0x80008
    s_waitcnt lgkmcnt(2)
    v_mfma_f32_4x4x4_16b_bf16 v[16:19], v[8:9], v[28:29], 0 cbsz:4 abid:11
    s_set_gpr_idx_mode 0x8
    ds_read_b64_tr_b16 v[24:25], v1 offset:3712
    ds_read_b64_tr_b16 v[26:27], v6 offset:3712
    v_fmac_f32 v85, v30, v43
    v_fmac_f32 v86, v31, v43
    v_fmac_f32 v87, v29, v43
    v_fmac_f32 v81, v16, v59
    v_fmac_f32 v82, v17, v59
    v_fmac_f32 v83, v18, v59
    v_fmac_f32 v84, v19, v75
    s_bfe_u32 m0, s42, 0x80010
    s_waitcnt lgkmcnt(2)
    v_mfma_f32_4x4x4_16b_bf16 v[16:19], v[8:9], v[20:21], 0 cbsz:4 abid:12
    s_set_gpr_idx_mode 0x8
    ds_read_b128 v[64:67], v0 offset:6144
    ds_read_b128 v[68:71], v0 offset:7168
    ds_read_b64_tr_b16 v[28:29], v1 offset:3840
    ds_read_b64_tr_b16 v[30:31], v6 offset:3840
    v_fmac_f32 v85, v22, v44
    v_fmac_f32 v86, v23, v44
    v_fmac_f32 v87, v21, v44
    v_fmac_f32 v81, v16, v60
    v_fmac_f32 v82, v17, v60
    v_fmac_f32 v83, v18, v60
    v_fmac_f32 v84, v19, v76
    s_bfe_u32 m0, s43, 0x80010
    s_waitcnt lgkmcnt(4)
    v_mfma_f32_4x4x4_16b_bf16 v[16:19], v[8:9], v[24:25], 0 cbsz:4 abid:13
    s_set_gpr_idx_mode 0x8
    ds_read_b64_tr_b16 v[20:21], v1 offset:3968
    ds_read_b64_tr_b16 v[22:23], v6 offset:3968
    v_fmac_f32 v85, v26, v45
    v_fmac_f32 v86, v27, v45
    v_fmac_f32 v87, v25, v45
    v_fmac_f32 v81, v16, v61
    v_fmac_f32 v82, v17, v61
    v_fmac_f32 v83, v18, v61
    v_fmac_f32 v84, v19, v77
    s_lshr_b32 m0, s42, 24
    s_waitcnt vmcnt(6) lgkmcnt(2)
    v_mfma_f32_4x4x4_16b_bf16 v[16:19], v[8:9], v[28:29], 0 cbsz:4 abid:14
    s_set_gpr_idx_mode 0x8
    ds_read_b128 v[24:27], v5 offset:0
    ds_read_b128 v[72:75], v0 offset:8192
    v_fmac_f32 v85, v30, v46
    v_fmac_f32 v86, v31, v46
    v_fmac_f32 v87, v29, v46
    v_fmac_f32 v81, v16, v62
    v_fmac_f32 v82, v17, v62
    v_fmac_f32 v83, v18, v62
    v_fmac_f32 v84, v19, v78
    s_lshr_b32 m0, s43, 24
    s_waitcnt lgkmcnt(2)
    v_mfma_f32_4x4x4_16b_bf16 v[16:19], v[8:9], v[20:21], 0 cbsz:4 abid:15
    s_set_gpr_idx_mode 0x8
    ds_read_b128 v[28:31], v80 offset:0
    v_fmac_f32 v85, v22, v47
    v_fmac_f32 v86, v23, v47
    v_fmac_f32 v87, v21, v47
    v_fmac_f32 v81, v16, v63
    v_fmac_f32 v82, v17, v63
    v_fmac_f32 v83, v18, v63
    v_fmac_f32 v84, v19, v79
    s_set_gpr_idx_off
    s_sub_u32 s39, s39, 1
    s_cbranch_scc1 tp_main_kernel_b_done
    s_waitcnt lgkmcnt(2)
    v_mfma_f32_32x32x16_bf16 v[32:47], v[24:27], v[64:67], 0
    ds_read_b128 v[76:79], v0 offset:9216
    ds_read_b128 v[20:23], v0 offset:2048
    ds_read_b128 v[16:19], v0 offset:3072
    v_mad_u32_u16 v12, v12, s78, v14 op_sel:[1,0,0,0]
    s_cmp_ge_i32 s39, 1
    s_cselect_b32 s80, s68, s69
    s_waitcnt lgkmcnt(3)
    v_mfma_f32_32x32x16_bf16 v[32:47], v[28:31], v[68:71], v[32:47]
    v_perm_b32 v8, v49, v48, v10
    v_perm_b32 v9, v49, v48, v11
    s_add_u32 m0, s33, 1920
    v_mfma_f32_32x32x16_bf16 v[48:63], v[24:27], v[72:75], 0
    buffer_load_dwordx4 v12, s[4:7], s80 offen offset:128 lds
    s_add_u32 m0, s33, 5952
    s_waitcnt lgkmcnt(0)
    buffer_load_dwordx4 v12, s[4:7], s80 offen offset:256 lds
    s_add_u32 m0, s33, 9984
    v_mad_u32_u16 v13, v13, s78, v14 op_sel:[1,0,0,0]
    buffer_load_dwordx4 v12, s[4:7], s80 offen offset:384 lds
    s_add_u32 m0, s33, 2944
    v_mfma_f32_32x32x16_bf16 v[48:63], v[28:31], v[76:79], v[48:63]
    buffer_load_dwordx4 v13, s[4:7], s80 offen offset:128 lds
    s_add_u32 m0, s33, 6976
    s_mul_i32 s40, s44, 7
    buffer_load_dwordx4 v13, s[4:7], s80 offen offset:256 lds
    s_add_u32 m0, s33, 11008
    s_mul_i32 s41, s45, 7
    buffer_load_dwordx4 v13, s[4:7], s80 offen offset:384 lds
    v_mfma_f32_32x32x16_bf16 v[64:79], v[24:27], v[20:23], 0
    s_waitcnt vmcnt(9)
    ds_read_b64_tr_b16 v[20:21], v1 offset:0
    ds_read_b64_tr_b16 v[22:23], v6 offset:0
    ds_read_b64_tr_b16 v[24:25], v1 offset:128
    ds_read_b64_tr_b16 v[26:27], v6 offset:128
    v_xor_b32 v8, v8, v7
    v_mfma_f32_32x32x16_bf16 v[64:79], v[28:31], v[16:19], v[64:79]
    ds_read2_b32 v[12:13], v2 offset0:128 offset1:144
    s_mul_i32 s42, s46, 7
    s_mul_i32 s43, s47, 7
    s_buffer_load_dwordx4 s[44:47], s[88:91], s92
    s_add_u32 s92, s92, 16
    s_setprio 3
    s_waitcnt lgkmcnt(3)
    v_mfma_f32_4x4x4_16b_bf16 v[16:19], v[8:9], v[20:21], 0 cbsz:4 abid:0
    s_set_gpr_idx_on s40, 0x8
    ds_read_b64_tr_b16 v[28:29], v1 offset:256
    ds_read_b64_tr_b16 v[30:31], v6 offset:256
    v_fmac_f32 v85, v22, v32
    v_fmac_f32 v86, v23, v32
    v_fmac_f32 v87, v21, v32
    v_fmac_f32 v81, v16, v48
    v_fmac_f32 v82, v17, v48
    v_fmac_f32 v83, v18, v48
    v_fmac_f32 v84, v19, v64
    s_bfe_u32 m0, s41, 0x80000
    s_waitcnt lgkmcnt(3)
    v_mfma_f32_4x4x4_16b_bf16 v[16:19], v[8:9], v[24:25], 0 cbsz:4 abid:1
    s_set_gpr_idx_mode 0x8
    ds_read_b64_tr_b16 v[20:21], v1 offset:384
    ds_read_b64_tr_b16 v[22:23], v6 offset:384
    v_fmac_f32 v85, v26, v33
    v_fmac_f32 v86, v27, v33
    v_fmac_f32 v87, v25, v33
    v_fmac_f32 v81, v16, v49
    v_fmac_f32 v82, v17, v49
    v_fmac_f32 v83, v18, v49
    v_fmac_f32 v84, v19, v65
    s_bfe_u32 m0, s40, 0x80008
    s_waitcnt lgkmcnt(2)
    v_mfma_f32_4x4x4_16b_bf16 v[16:19], v[8:9], v[28:29], 0 cbsz:4 abid:2
    s_set_gpr_idx_mode 0x8
    ds_read_b64_tr_b16 v[24:25], v1 offset:512
    ds_read_b64_tr_b16 v[26:27], v6 offset:512
    v_fmac_f32 v85, v30, v34
    v_fmac_f32 v86, v31, v34
    v_fmac_f32 v87, v29, v34
    v_fmac_f32 v81, v16, v50
    v_fmac_f32 v82, v17, v50
    v_fmac_f32 v83, v18, v50
    v_fmac_f32 v84, v19, v66
    s_bfe_u32 m0, s41, 0x80008
    s_waitcnt lgkmcnt(2)
    v_mfma_f32_4x4x4_16b_bf16 v[16:19], v[8:9], v[20:21], 0 cbsz:4 abid:3
    s_set_gpr_idx_mode 0x8
    ds_read_b64_tr_b16 v[28:29], v1 offset:640
    ds_read_b64_tr_b16 v[30:31], v6 offset:640
    v_fmac_f32 v85, v22, v35
    v_fmac_f32 v86, v23, v35
    v_fmac_f32 v87, v21, v35
    v_fmac_f32 v81, v16, v51
    v_fmac_f32 v82, v17, v51
    v_fmac_f32 v83, v18, v51
    v_fmac_f32 v84, v19, v67
    s_bfe_u32 m0, s40, 0x80010
    s_waitcnt lgkmcnt(2)
    v_mfma_f32_4x4x4_16b_bf16 v[16:19], v[8:9], v[24:25], 0 cbsz:4 abid:4
    s_set_gpr_idx_mode 0x8
    ds_read_b64 v[48:49], v3 offset:11136
    ds_read_b64_tr_b16 v[20:21], v1 offset:768
    ds_read_b64_tr_b16 v[22:23], v6 offset:768
    v_fmac_f32 v85, v26, v36
    v_fmac_f32 v86, v27, v36
    v_fmac_f32 v87, v25, v36
    v_fmac_f32 v81, v16, v52
    v_fmac_f32 v82, v17, v52
    v_fmac_f32 v83, v18, v52
    v_fmac_f32 v84, v19, v68
    s_bfe_u32 m0, s41, 0x80010
    s_waitcnt lgkmcnt(3)
    v_mfma_f32_4x4x4_16b_bf16 v[16:19], v[8:9], v[28:29], 0 cbsz:4 abid:5
    s_set_gpr_idx_mode 0x8
    ds_read_b64_tr_b16 v[24:25], v1 offset:896
    ds_read_b64_tr_b16 v[26:27], v6 offset:896
    v_fmac_f32 v85, v30, v37
    v_fmac_f32 v86, v31, v37
    v_fmac_f32 v87, v29, v37
    v_fmac_f32 v81, v16, v53
    v_fmac_f32 v82, v17, v53
    v_fmac_f32 v83, v18, v53
    v_fmac_f32 v84, v19, v69
    s_lshr_b32 m0, s40, 24
    s_waitcnt vmcnt(6) lgkmcnt(2)
    v_mfma_f32_4x4x4_16b_bf16 v[16:19], v[8:9], v[20:21], 0 cbsz:4 abid:6
    s_set_gpr_idx_mode 0x8
    ds_read_b32 v51, v4 offset:40768
    ds_read_b64_tr_b16 v[28:29], v1 offset:1024
    ds_read_b64_tr_b16 v[30:31], v6 offset:1024
    v_fmac_f32 v85, v22, v38
    v_fmac_f32 v86, v23, v38
    v_fmac_f32 v87, v21, v38
    v_fmac_f32 v81, v16, v54
    v_fmac_f32 v82, v17, v54
    v_fmac_f32 v83, v18, v54
    v_fmac_f32 v84, v19, v70
    s_lshr_b32 m0, s41, 24
    s_waitcnt lgkmcnt(3)
    v_mfma_f32_4x4x4_16b_bf16 v[16:19], v[8:9], v[24:25], 0 cbsz:4 abid:7
    s_set_gpr_idx_mode 0x8
    ds_read_b64_tr_b16 v[20:21], v1 offset:1152
    ds_read_b64_tr_b16 v[22:23], v6 offset:1152
    v_fmac_f32 v85, v26, v39
    v_fmac_f32 v86, v27, v39
    v_fmac_f32 v87, v25, v39
    v_fmac_f32 v81, v16, v55
    v_fmac_f32 v82, v17, v55
    v_fmac_f32 v83, v18, v55
    v_fmac_f32 v84, v19, v71
    s_bfe_u32 m0, s42, 0x80000
    s_cmp_eq_u32 s39, s82
    s_cbranch_scc1 tp_main_kernel_b_done
    s_waitcnt lgkmcnt(2)
    v_mfma_f32_4x4x4_16b_bf16 v[16:19], v[8:9], v[28:29], 0 cbsz:4 abid:8
    s_set_gpr_idx_mode 0x8
    ds_read_b64_tr_b16 v[24:25], v1 offset:1280
    ds_read_b64_tr_b16 v[26:27], v6 offset:1280
    v_fmac_f32 v85, v30, v40
    v_fmac_f32 v86, v31, v40
    v_fmac_f32 v87, v29, v40
    v_fmac_f32 v81, v16, v56
    v_fmac_f32 v82, v17, v56
    v_fmac_f32 v83, v18, v56
    v_fmac_f32 v84, v19, v72
    s_bfe_u32 m0, s43, 0x80000
    s_waitcnt lgkmcnt(2)
    v_mfma_f32_4x4x4_16b_bf16 v[16:19], v[8:9], v[20:21], 0 cbsz:4 abid:9
    s_set_gpr_idx_mode 0x8
    ds_read_b64_tr_b16 v[28:29], v1 offset:1408
    ds_read_b64_tr_b16 v[30:31], v6 offset:1408
    v_fmac_f32 v85, v22, v41
    v_fmac_f32 v86, v23, v41
    v_fmac_f32 v87, v21, v41
    v_fmac_f32 v81, v16, v57
    v_fmac_f32 v82, v17, v57
    v_fmac_f32 v83, v18, v57
    v_fmac_f32 v84, v19, v73
    s_bfe_u32 m0, s42, 0x80008
    s_waitcnt lgkmcnt(2)
    v_mfma_f32_4x4x4_16b_bf16 v[16:19], v[8:9], v[24:25], 0 cbsz:4 abid:10
    s_set_gpr_idx_mode 0x8
    ds_read_b64_tr_b16 v[20:21], v1 offset:1536
    ds_read_b64_tr_b16 v[22:23], v6 offset:1536
    v_fmac_f32 v85, v26, v42
    v_fmac_f32 v86, v27, v42
    v_fmac_f32 v87, v25, v42
    v_fmac_f32 v81, v16, v58
    v_fmac_f32 v82, v17, v58
    v_fmac_f32 v83, v18, v58
    v_fmac_f32 v84, v19, v74
    s_bfe_u32 m0, s43, 0x80008
    s_waitcnt lgkmcnt(2)
    v_mfma_f32_4x4x4_16b_bf16 v[16:19], v[8:9], v[28:29], 0 cbsz:4 abid:11
    s_set_gpr_idx_mode 0x8
    ds_read_b64_tr_b16 v[24:25], v1 offset:1664
    ds_read_b64_tr_b16 v[26:27], v6 offset:1664
    v_fmac_f32 v85, v30, v43
    v_fmac_f32 v86, v31, v43
    v_fmac_f32 v87, v29, v43
    v_fmac_f32 v81, v16, v59
    v_fmac_f32 v82, v17, v59
    v_fmac_f32 v83, v18, v59
    v_fmac_f32 v84, v19, v75
    s_bfe_u32 m0, s42, 0x80010
    s_waitcnt lgkmcnt(2)
    v_mfma_f32_4x4x4_16b_bf16 v[16:19], v[8:9], v[20:21], 0 cbsz:4 abid:12
    s_set_gpr_idx_mode 0x8
    ds_read_b128 v[64:67], v0 offset:6144
    ds_read_b128 v[68:71], v0 offset:7168
    ds_read_b64_tr_b16 v[28:29], v1 offset:1792
    ds_read_b64_tr_b16 v[30:31], v6 offset:1792
    v_fmac_f32 v85, v22, v44
    v_fmac_f32 v86, v23, v44
    v_fmac_f32 v87, v21, v44
    v_fmac_f32 v81, v16, v60
    v_fmac_f32 v82, v17, v60
    v_fmac_f32 v83, v18, v60
    v_fmac_f32 v84, v19, v76
    s_bfe_u32 m0, s43, 0x80010
    s_waitcnt lgkmcnt(4)
    v_mfma_f32_4x4x4_16b_bf16 v[16:19], v[8:9], v[24:25], 0 cbsz:4 abid:13
    s_set_gpr_idx_mode 0x8
    ds_read_b64_tr_b16 v[20:21], v1 offset:1920
    ds_read_b64_tr_b16 v[22:23], v6 offset:1920
    v_fmac_f32 v85, v26, v45
    v_fmac_f32 v86, v27, v45
    v_fmac_f32 v87, v25, v45
    v_fmac_f32 v81, v16, v61
    v_fmac_f32 v82, v17, v61
    v_fmac_f32 v83, v18, v61
    v_fmac_f32 v84, v19, v77
    s_lshr_b32 m0, s42, 24
    s_waitcnt lgkmcnt(2)
    v_mfma_f32_4x4x4_16b_bf16 v[16:19], v[8:9], v[28:29], 0 cbsz:4 abid:14
    s_set_gpr_idx_mode 0x8
    ds_read_b128 v[24:27], v5 offset:512
    ds_read_b128 v[72:75], v0 offset:8192
    v_fmac_f32 v85, v30, v46
    v_fmac_f32 v86, v31, v46
    v_fmac_f32 v87, v29, v46
    v_fmac_f32 v81, v16, v62
    v_fmac_f32 v82, v17, v62
    v_fmac_f32 v83, v18, v62
    v_fmac_f32 v84, v19, v78
    s_lshr_b32 m0, s43, 24
    s_waitcnt lgkmcnt(2)
    v_mfma_f32_4x4x4_16b_bf16 v[16:19], v[8:9], v[20:21], 0 cbsz:4 abid:15
    s_set_gpr_idx_mode 0x8
    ds_read_b128 v[28:31], v80 offset:512
    v_fmac_f32 v85, v22, v47
    v_fmac_f32 v86, v23, v47
    v_fmac_f32 v87, v21, v47
    v_fmac_f32 v81, v16, v63
    v_fmac_f32 v82, v17, v63
    v_fmac_f32 v83, v18, v63
    v_fmac_f32 v84, v19, v79
    s_set_gpr_idx_off
    s_sub_u32 s39, s39, 1
    s_cbranch_scc1 tp_main_kernel_b_done
    s_waitcnt lgkmcnt(2)
    v_mfma_f32_32x32x16_bf16 v[32:47], v[24:27], v[64:67], 0
    ds_read_b128 v[76:79], v0 offset:9216
    ds_read_b128 v[20:23], v0 offset:2048
    ds_read_b128 v[16:19], v0 offset:3072
    v_mad_u32_u16 v12, v12, s78, v14 op_sel:[1,0,0,0]
    s_cmp_ge_i32 s39, 1
    s_cselect_b32 s80, s68, s69
    s_waitcnt lgkmcnt(3)
    v_mfma_f32_32x32x16_bf16 v[32:47], v[28:31], v[68:71], v[32:47]
    s_add_u32 m0, s33, 12416
    v_bfi_b32 v51, 31, v0, v51
    buffer_load_dwordx4 v51, s[8:11], s80 offen lds
    v_perm_b32 v8, v49, v48, v10
    v_perm_b32 v9, v49, v48, v11
    s_add_u32 m0, s33, -128
    v_mfma_f32_32x32x16_bf16 v[48:63], v[24:27], v[72:75], 0
    buffer_load_dwordx4 v12, s[4:7], s80 offen offset:128 lds
    s_add_u32 m0, s33, 3904
    s_waitcnt lgkmcnt(0)
    buffer_load_dwordx4 v12, s[4:7], s80 offen offset:256 lds
    s_add_u32 m0, s33, 7936
    v_mad_u32_u16 v13, v13, s78, v14 op_sel:[1,0,0,0]
    buffer_load_dwordx4 v12, s[4:7], s80 offen offset:384 lds
    s_add_u32 m0, s33, 896
    v_mfma_f32_32x32x16_bf16 v[48:63], v[28:31], v[76:79], v[48:63]
    buffer_load_dwordx4 v13, s[4:7], s80 offen offset:128 lds
    s_add_u32 m0, s33, 4928
    s_mul_i32 s40, s44, 7
    buffer_load_dwordx4 v13, s[4:7], s80 offen offset:256 lds
    s_add_u32 m0, s33, 8960
    s_mul_i32 s41, s45, 7
    buffer_load_dwordx4 v13, s[4:7], s80 offen offset:384 lds
    v_mfma_f32_32x32x16_bf16 v[64:79], v[24:27], v[20:23], 0
    s_waitcnt vmcnt(10)
    ds_read_b64_tr_b16 v[20:21], v1 offset:2048
    ds_read_b64_tr_b16 v[22:23], v6 offset:2048
    ds_read_b64_tr_b16 v[24:25], v1 offset:2176
    ds_read_b64_tr_b16 v[26:27], v6 offset:2176
    v_xor_b32 v8, v8, v7
    v_mfma_f32_32x32x16_bf16 v[64:79], v[28:31], v[16:19], v[64:79]
    ds_read2_b32 v[12:13], v2 offset0:160 offset1:176
    s_mul_i32 s42, s46, 7
    s_mul_i32 s43, s47, 7
    s_buffer_load_dwordx4 s[44:47], s[88:91], s92
    s_add_u32 s92, s92, 16
    v_add_u32 v2, 512, v2
    v_add_u32 v3, 512, v3
    v_add_u32 v4, 256, v4
    s_add_u32 s81, s81, 64
    s_waitcnt lgkmcnt(3)
    v_mfma_f32_4x4x4_16b_bf16 v[16:19], v[8:9], v[20:21], 0 cbsz:4 abid:0
    s_set_gpr_idx_on s40, 0x8
    ds_read_b64_tr_b16 v[28:29], v1 offset:2304
    ds_read_b64_tr_b16 v[30:31], v6 offset:2304
    v_fmac_f32 v85, v22, v32
    v_fmac_f32 v86, v23, v32
    v_fmac_f32 v87, v21, v32
    v_fmac_f32 v81, v16, v48
    v_fmac_f32 v82, v17, v48
    v_fmac_f32 v83, v18, v48
    v_fmac_f32 v84, v19, v64
    s_bfe_u32 m0, s41, 0x80000
    s_waitcnt lgkmcnt(3)
    v_mfma_f32_4x4x4_16b_bf16 v[16:19], v[8:9], v[24:25], 0 cbsz:4 abid:1
    s_set_gpr_idx_mode 0x8
    ds_read_b64_tr_b16 v[20:21], v1 offset:2432
    ds_read_b64_tr_b16 v[22:23], v6 offset:2432
    v_fmac_f32 v85, v26, v33
    v_fmac_f32 v86, v27, v33
    v_fmac_f32 v87, v25, v33
    v_fmac_f32 v81, v16, v49
    v_fmac_f32 v82, v17, v49
    v_fmac_f32 v83, v18, v49
    v_fmac_f32 v84, v19, v65
    s_bfe_u32 m0, s40, 0x80008
    s_waitcnt lgkmcnt(2)
    v_mfma_f32_4x4x4_16b_bf16 v[16:19], v[8:9], v[28:29], 0 cbsz:4 abid:2
    s_set_gpr_idx_mode 0x8
    ds_read_b64_tr_b16 v[24:25], v1 offset:2560
    ds_read_b64_tr_b16 v[26:27], v6 offset:2560
    v_fmac_f32 v85, v30, v34
    v_fmac_f32 v86, v31, v34
    v_fmac_f32 v87, v29, v34
    v_fmac_f32 v81, v16, v50
    v_fmac_f32 v82, v17, v50
    v_fmac_f32 v83, v18, v50
    v_fmac_f32 v84, v19, v66
    s_bfe_u32 m0, s41, 0x80008
    s_waitcnt lgkmcnt(2)
    v_mfma_f32_4x4x4_16b_bf16 v[16:19], v[8:9], v[20:21], 0 cbsz:4 abid:3
    s_set_gpr_idx_mode 0x8
    ds_read_b64_tr_b16 v[28:29], v1 offset:2688
    ds_read_b64_tr_b16 v[30:31], v6 offset:2688
    v_fmac_f32 v85, v22, v35
    v_fmac_f32 v86, v23, v35
    v_fmac_f32 v87, v21, v35
    v_fmac_f32 v81, v16, v51
    v_fmac_f32 v82, v17, v51
    v_fmac_f32 v83, v18, v51
    v_fmac_f32 v84, v19, v67
    s_bfe_u32 m0, s40, 0x80010
    s_waitcnt lgkmcnt(2)
    v_mfma_f32_4x4x4_16b_bf16 v[16:19], v[8:9], v[24:25], 0 cbsz:4 abid:4
    s_set_gpr_idx_mode 0x8
    ds_read_b64 v[48:49], v3 offset:10752
    ds_read_b64_tr_b16 v[20:21], v1 offset:2816
    ds_read_b64_tr_b16 v[22:23], v6 offset:2816
    v_fmac_f32 v85, v26, v36
    v_fmac_f32 v86, v27, v36
    v_fmac_f32 v87, v25, v36
    v_fmac_f32 v81, v16, v52
    v_fmac_f32 v82, v17, v52
    v_fmac_f32 v83, v18, v52
    v_fmac_f32 v84, v19, v68
    s_bfe_u32 m0, s41, 0x80010
    s_waitcnt lgkmcnt(3)
    v_mfma_f32_4x4x4_16b_bf16 v[16:19], v[8:9], v[28:29], 0 cbsz:4 abid:5
    s_set_gpr_idx_mode 0x8
    ds_read_b64_tr_b16 v[24:25], v1 offset:2944
    ds_read_b64_tr_b16 v[26:27], v6 offset:2944
    v_fmac_f32 v85, v30, v37
    v_fmac_f32 v86, v31, v37
    v_fmac_f32 v87, v29, v37
    v_fmac_f32 v81, v16, v53
    v_fmac_f32 v82, v17, v53
    v_fmac_f32 v83, v18, v53
    v_fmac_f32 v84, v19, v69
    s_lshr_b32 m0, s40, 24
    s_setprio 2
    s_cmp_lt_u32 s3, 4
    s_cbranch_scc1 1
    s_setprio 3
    s_waitcnt vmcnt(7) lgkmcnt(2)
    v_mfma_f32_4x4x4_16b_bf16 v[16:19], v[8:9], v[20:21], 0 cbsz:4 abid:6
    s_set_gpr_idx_mode 0x8
    ds_read_b64_tr_b16 v[28:29], v1 offset:3072
    ds_read_b64_tr_b16 v[30:31], v6 offset:3072
    v_fmac_f32 v85, v22, v38
    v_fmac_f32 v86, v23, v38
    v_fmac_f32 v87, v21, v38
    v_fmac_f32 v81, v16, v54
    v_fmac_f32 v82, v17, v54
    v_fmac_f32 v83, v18, v54
    v_fmac_f32 v84, v19, v70
    s_lshr_b32 m0, s41, 24
    s_waitcnt lgkmcnt(2)
    v_mfma_f32_4x4x4_16b_bf16 v[16:19], v[8:9], v[24:25], 0 cbsz:4 abid:7
    s_set_gpr_idx_mode 0x8
    ds_read_b64_tr_b16 v[20:21], v1 offset:3200
    ds_read_b64_tr_b16 v[22:23], v6 offset:3200
    v_fmac_f32 v85, v26, v39
    v_fmac_f32 v86, v27, v39
    v_fmac_f32 v87, v25, v39
    v_fmac_f32 v81, v16, v55
    v_fmac_f32 v82, v17, v55
    v_fmac_f32 v83, v18, v55
    v_fmac_f32 v84, v19, v71
    s_bfe_u32 m0, s42, 0x80000
    s_cmp_eq_u32 s39, s82
    s_cbranch_scc1 tp_main_kernel_b_done
    s_waitcnt lgkmcnt(2)
    v_mfma_f32_4x4x4_16b_bf16 v[16:19], v[8:9], v[28:29], 0 cbsz:4 abid:8
    s_set_gpr_idx_mode 0x8
    ds_read_b64_tr_b16 v[24:25], v1 offset:3328
    ds_read_b64_tr_b16 v[26:27], v6 offset:3328
    v_fmac_f32 v85, v30, v40
    v_fmac_f32 v86, v31, v40
    v_fmac_f32 v87, v29, v40
    v_fmac_f32 v81, v16, v56
    v_fmac_f32 v82, v17, v56
    v_fmac_f32 v83, v18, v56
    v_fmac_f32 v84, v19, v72
    s_bfe_u32 m0, s43, 0x80000
    s_waitcnt lgkmcnt(2)
    v_mfma_f32_4x4x4_16b_bf16 v[16:19], v[8:9], v[20:21], 0 cbsz:4 abid:9
    s_set_gpr_idx_mode 0x8
    ds_read_b64_tr_b16 v[28:29], v1 offset:3456
    ds_read_b64_tr_b16 v[30:31], v6 offset:3456
    v_fmac_f32 v85, v22, v41
    v_fmac_f32 v86, v23, v41
    v_fmac_f32 v87, v21, v41
    v_fmac_f32 v81, v16, v57
    v_fmac_f32 v82, v17, v57
    v_fmac_f32 v83, v18, v57
    v_fmac_f32 v84, v19, v73
    s_bfe_u32 m0, s42, 0x80008
    s_waitcnt lgkmcnt(2)
    v_mfma_f32_4x4x4_16b_bf16 v[16:19], v[8:9], v[24:25], 0 cbsz:4 abid:10
    s_set_gpr_idx_mode 0x8
    ds_read_b64_tr_b16 v[20:21], v1 offset:3584
    ds_read_b64_tr_b16 v[22:23], v6 offset:3584
    v_fmac_f32 v85, v26, v42
    v_fmac_f32 v86, v27, v42
    v_fmac_f32 v87, v25, v42
    v_fmac_f32 v81, v16, v58
    v_fmac_f32 v82, v17, v58
    v_fmac_f32 v83, v18, v58
    v_fmac_f32 v84, v19, v74
    s_bfe_u32 m0, s43, 0x80008
    s_waitcnt lgkmcnt(2)
    v_mfma_f32_4x4x4_16b_bf16 v[16:19], v[8:9], v[28:29], 0 cbsz:4 abid:11
    s_set_gpr_idx_mode 0x8
    ds_read_b64_tr_b16 v[24:25], v1 offset:3712
    ds_read_b64_tr_b16 v[26:27], v6 offset:3712
    v_fmac_f32 v85, v30, v43
    v_fmac_f32 v86, v31, v43
    v_fmac_f32 v87, v29, v43
    v_fmac_f32 v81, v16, v59
    v_fmac_f32 v82, v17, v59
    v_fmac_f32 v83, v18, v59
    v_fmac_f32 v84, v19, v75
    s_bfe_u32 m0, s42, 0x80010
    s_waitcnt lgkmcnt(2)
    v_mfma_f32_4x4x4_16b_bf16 v[16:19], v[8:9], v[20:21], 0 cbsz:4 abid:12
    s_set_gpr_idx_mode 0x8
    ds_read_b128 v[64:67], v0 offset:6144
    ds_read_b128 v[68:71], v0 offset:7168
    ds_read_b64_tr_b16 v[28:29], v1 offset:3840
    ds_read_b64_tr_b16 v[30:31], v6 offset:3840
    v_fmac_f32 v85, v22, v44
    v_fmac_f32 v86, v23, v44
    v_fmac_f32 v87, v21, v44
    v_fmac_f32 v81, v16, v60
    v_fmac_f32 v82, v17, v60
    v_fmac_f32 v83, v18, v60
    v_fmac_f32 v84, v19, v76
    s_bfe_u32 m0, s43, 0x80010
    s_waitcnt lgkmcnt(4)
    v_mfma_f32_4x4x4_16b_bf16 v[16:19], v[8:9], v[24:25], 0 cbsz:4 abid:13
    s_set_gpr_idx_mode 0x8
    ds_read_b64_tr_b16 v[20:21], v1 offset:3968
    ds_read_b64_tr_b16 v[22:23], v6 offset:3968
    v_fmac_f32 v85, v26, v45
    v_fmac_f32 v86, v27, v45
    v_fmac_f32 v87, v25, v45
    v_fmac_f32 v81, v16, v61
    v_fmac_f32 v82, v17, v61
    v_fmac_f32 v83, v18, v61
    v_fmac_f32 v84, v19, v77
    s_lshr_b32 m0, s42, 24
    s_waitcnt vmcnt(6) lgkmcnt(2)
    v_mfma_f32_4x4x4_16b_bf16 v[16:19], v[8:9], v[28:29], 0 cbsz:4 abid:14
    s_set_gpr_idx_mode 0x8
    ds_read_b128 v[24:27], v5 offset:0
    ds_read_b128 v[72:75], v0 offset:8192
    v_fmac_f32 v85, v30, v46
    v_fmac_f32 v86, v31, v46
    v_fmac_f32 v87, v29, v46
    v_fmac_f32 v81, v16, v62
    v_fmac_f32 v82, v17, v62
    v_fmac_f32 v83, v18, v62
    v_fmac_f32 v84, v19, v78
    s_lshr_b32 m0, s43, 24
    s_waitcnt lgkmcnt(2)
    v_mfma_f32_4x4x4_16b_bf16 v[16:19], v[8:9], v[20:21], 0 cbsz:4 abid:15
    s_set_gpr_idx_mode 0x8
    ds_read_b128 v[28:31], v80 offset:0
    v_fmac_f32 v85, v22, v47
    v_fmac_f32 v86, v23, v47
    v_fmac_f32 v87, v21, v47
    v_fmac_f32 v81, v16, v63
    v_fmac_f32 v82, v17, v63
    v_fmac_f32 v83, v18, v63
    v_fmac_f32 v84, v19, v79
    s_set_gpr_idx_off
    s_sub_u32 s39, s39, 1
    s_cbranch_scc1 tp_main_kernel_b_done
    s_branch tp_main_kernel_b_loop
tp_main_kernel_b_ahead:
    v_min_u32 v32, 384, v0
    v_lshlrev_b32 v32, 5, v32
    s_mov_b32 s71, -100
    buffer_load_dword v15, v32, s[4:7], s79 offen
    s_branch tp_main_kernel_b_back
tp_main_kernel_b_done:
    s_set_gpr_idx_off
    s_waitcnt vmcnt(0) lgkmcnt(0)
    s_setprio 0
    s_add_u32 m0, s33, 8192
    s_mul_i32 s49, s3, 5120
    s_add_u32 s49, s49, 10240
    buffer_load_dwordx4 v0, s[20:23], s49 offen offset:0 lds
    buffer_load_dwordx4 v0, s[20:23], s49 offen offset:1024 lds
    buffer_load_dwordx4 v0, s[20:23], s49 offen offset:2048 lds
    buffer_load_dwordx4 v0, s[20:23], s49 offen offset:3072 lds
    s_add_u32 m0, s33, 12288
    s_add_u32 s49, s49, 4096
    buffer_load_dwordx4 v0, s[20:23], s49 offen lds
    s_lshl_b32 s48, s81, 3
    s_lshl_b32 s49, s81, 2
    v_subrev_u32 v2, s48, v2
    v_subrev_u32 v4, s49, v4
    v_lshrrev_b32 v17, 1, v14
    ds_read_u16 v32, v2 offset:2
    ds_read_u16 v33, v2 offset:66
    ds_read_u16 v34, v2 offset:130
    ds_read_u16 v35, v2 offset:194
    ds_read_u16 v36, v2 offset:258
    ds_read_b32 v40, v4 offset:40512
    ds_read_b32 v42, v4 offset:40640
    ds_read_b64 v[8:9], v17 offset:10304
    v_subrev_u32 v3, s48, v3
    s_mov_b32 s92, s70
    s_buffer_load_dwordx4 s[44:47], s[88:91], s92
    s_add_u32 s92, s92, 16
    v_bfe_u32 v17, v0, 7, 1
    v_mul_u32_u24 v17, 4032, v17
    v_sub_u32 v1, v6, v17
    v_subrev_u32 v5, 6272, v5
    v_subrev_u32 v7, 6272, v80
    s_sub_u32 s39, s38, 1
    s_waitcnt lgkmcnt(0)
    v_lshl_or_b32 v32, v32, 9, v14
    v_lshl_or_b32 v33, v33, 9, v14
    v_lshl_or_b32 v34, v34, 9, v14
    v_lshl_or_b32 v35, v35, 9, v14
    v_lshl_or_b32 v36, v36, 9, v14
    v_mov_b32 v6, v8
    s_cmp_ge_i32 s39, 0
    s_cselect_b32 s80, s68, s69
    s_add_u32 m0, s33, 0
    s_nop 0
    buffer_load_dwordx4 v32, s[4:7], s80 offen lds
    s_add_u32 m0, s33, 6144
    v_bfi_b32 v40, 31, v0, v40
    buffer_load_dwordx4 v40, s[8:11], s80 offen lds
    s_add_u32 m0, s33, 1024
    s_nop 0
    buffer_load_dwordx4 v33, s[4:7], s80 offen lds
    s_cmp_ge_i32 s39, 1
    s_cselect_b32 s80, s68, s69
    s_add_u32 m0, s33, 2048
    s_nop 0
    buffer_load_dwordx4 v34, s[4:7], s80 offen lds
    s_add_u32 m0, s33, 3072
    s_nop 0
    buffer_load_dwordx4 v35, s[4:7], s80 offen lds
    s_cmp_ge_i32 s39, 2
    s_cselect_b32 s80, s68, s69
    s_add_u32 m0, s33, 4096
    s_nop 0
    buffer_load_dwordx4 v36, s[4:7], s80 offen lds
    s_add_u32 m0, s33, 7168
    v_bfi_b32 v42, 31, v0, v42
    buffer_load_dwordx4 v42, s[8:11], s80 offen lds
    ds_read_b128 v[24:27], v0 offset:4096
    ds_read_b128 v[28:31], v0 offset:5120
    v_cvt_pk_bf16_f32 v68, v84, v91
    v_cvt_pk_bf16_f32 v80, v85, v92
    v_cvt_pk_bf16_f32 v92, v81, v88
    v_cvt_pk_bf16_f32 v69, v98, v105
    v_cvt_pk_bf16_f32 v81, v99, v106
    v_cvt_pk_bf16_f32 v105, v100, v107
    v_cvt_pk_bf16_f32 v70, v112, v119
    v_cvt_pk_bf16_f32 v106, v114, v121
    v_cvt_pk_bf16_f32 v119, -v124, -v131
    v_cvt_pk_bf16_f32 v71, v126, v133
    v_cvt_pk_bf16_f32 v107, v128, v135
    v_cvt_pk_bf16_f32 v128, v87, v94
    v_cvt_pk_bf16_f32 v94, v109, v116
    v_cvt_pk_bf16_f32 v116, -v82, -v89
    v_cvt_pk_bf16_f32 v82, v113, v120
    v_cvt_pk_bf16_f32 v131, v129, v136
    v_cvt_pk_bf16_f32 v129, v101, v108
    v_cvt_pk_bf16_f32 v120, -v138, -v145
    v_cvt_pk_bf16_f32 v72, v140, v147
    v_cvt_pk_bf16_f32 v140, v83, v90
    v_cvt_pk_bf16_f32 v83, v127, v134
    v_cvt_pk_bf16_f32 v84, v141, v148
    v_cvt_pk_bf16_f32 v141, v97, v104
    v_cvt_pk_bf16_f32 v104, v86, v93
    v_cvt_pk_bf16_f32 v93, v95, v102
    v_cvt_pk_bf16_f32 v95, v123, v130
    v_cvt_pk_bf16_f32 v130, v115, v122
    v_cvt_pk_bf16_f32 v108, v142, v149
    v_cvt_pk_bf16_f32 v142, v111, v118
    v_cvt_pk_bf16_f32 v118, -v110, -v117
    v_cvt_pk_bf16_f32 v117, -v96, -v103
    v_cvt_pk_bf16_f32 v96, v137, v144
    v_cvt_pk_bf16_f32 v144, v139, v146
    v_cvt_pk_bf16_f32 v97, v151, v158
    v_cvt_pk_bf16_f32 v121, -v152, -v159
    v_cvt_pk_bf16_f32 v145, v153, v160
    v_cvt_pk_bf16_f32 v73, v154, v161
    v_cvt_pk_bf16_f32 v85, v155, v162
    v_cvt_pk_bf16_f32 v109, v156, v163
    v_cvt_pk_bf16_f32 v133, v157, v164
    v_cvt_pk_bf16_f32 v98, v165, v172
    v_cvt_pk_bf16_f32 v122, -v166, -v173
    v_cvt_pk_bf16_f32 v146, v167, v174
    v_cvt_pk_bf16_f32 v74, v168, v175
    v_cvt_pk_bf16_f32 v86, v169, v176
    v_cvt_pk_bf16_f32 v110, v170, v177
    v_cvt_pk_bf16_f32 v134, v171, v178
    v_cvt_pk_bf16_f32 v99, v179, v186
    v_cvt_pk_bf16_f32 v123, -v180, -v187
    v_cvt_pk_bf16_f32 v147, v181, v188
    v_cvt_pk_bf16_f32 v75, v182, v189
    v_cvt_pk_bf16_f32 v87, v183, v190
    v_cvt_pk_bf16_f32 v111, v184, v191
    v_cvt_pk_bf16_f32 v135, v185, v192
    v_cvt_pk_bf16_f32 v100, v193, v200
    v_cvt_pk_bf16_f32 v124, -v194, -v201
    v_cvt_pk_bf16_f32 v148, v195, v202
    v_cvt_pk_bf16_f32 v76, v196, v203
    v_cvt_pk_bf16_f32 v88, v197, v204
    v_cvt_pk_bf16_f32 v112, v198, v205
    v_cvt_pk_bf16_f32 v136, v199, v206
    v_cvt_pk_bf16_f32 v101, v207, v214
    v_cvt_pk_bf16_f32 v149, v209, v216
    v_cvt_pk_bf16_f32 v77, v210, v217
    v_cvt_pk_bf16_f32 v89, v211, v218
    v_cvt_pk_bf16_f32 v113, v212, v219
    v_cvt_pk_bf16_f32 v137, v213, v220
    v_cvt_pk_bf16_f32 v102, v221, v228
    v_cvt_pk_bf16_f32 v126, -v222, -v229
    v_cvt_pk_bf16_f32 v78, v224, v231
    v_cvt_pk_bf16_f32 v90, v225, v232
    v_cvt_pk_bf16_f32 v114, v226, v233
    v_cvt_pk_bf16_f32 v138, v227, v234
    v_cvt_pk_bf16_f32 v103, v235, v242
    v_cvt_pk_bf16_f32 v127, -v236, -v243
    v_cvt_pk_bf16_f32 v151, v237, v244
    v_cvt_pk_bf16_f32 v79, v238, v245
    v_cvt_pk_bf16_f32 v91, v239, v246
    v_cvt_pk_bf16_f32 v115, v240, v247
    v_cvt_pk_bf16_f32 v139, v241, v248
    v_cvt_pk_bf16_f32 v152, v249, -v250
    v_cvt_pk_bf16_f32 v153, v251, v252
    v_cvt_pk_bf16_f32 v154, v253, v254
    v_cvt_pk_bf16_f32 v155, v255, v255
    v_cvt_pk_bf16_f32 v63, v125, v132
    v_cvt_pk_bf16_f32 v132, v143, v150
    v_cvt_pk_bf16_f32 v125, -v208, -v215
    v_cvt_pk_bf16_f32 v150, v223, v230
    v_mov_b32 v143, v63
    v_mov_b64 v[156:157], 0
    v_mov_b64 v[158:159], 0
    v_mov_b64 v[160:161], 0
    v_mov_b64 v[162:163], 0
    v_mov_b64 v[164:165], 0
    v_mov_b64 v[166:167], 0
    v_mov_b64 v[168:169], 0
    v_mov_b64 v[170:171], 0
    v_mov_b64 v[172:173], 0
    v_mov_b64 v[174:175], 0
    v_mov_b64 v[176:177], 0
    v_mov_b64 v[178:179], 0
    v_mov_b64 v[180:181], 0
    v_mov_b64 v[182:183], 0
    v_mov_b64 v[184:185], 0
    v_mov_b64 v[186:187], 0
    v_mov_b64 v[188:189], 0
    v_mov_b64 v[190:191], 0
    v_mov_b64 v[192:193], 0
    v_mov_b64 v[194:195], 0
    v_mov_b64 v[196:197], 0
    v_mov_b64 v[198:199], 0
    v_mov_b64 v[200:201], 0
    v_mov_b64 v[202:203], 0
    v_mov_b64 v[204:205], 0
    v_mov_b64 v[206:207], 0
    v_mov_b64 v[208:209], 0
    v_mov_b64 v[210:211], 0
    v_mov_b64 v[212:213], 0
    v_mov_b64 v[214:215], 0
    v_mov_b64 v[216:217], 0
    v_mov_b64 v[218:219], 0
    v_mov_b64 v[220:221], 0
    v_mov_b64 v[222:223], 0
    v_mov_b64 v[224:225], 0
    v_mov_b64 v[226:227], 0
    v_mov_b64 v[228:229], 0
    v_mov_b64 v[230:231], 0
    v_mov_b64 v[232:233], 0
    v_mov_b64 v[234:235], 0
    v_mov_b64 v[236:237], 0
    v_mov_b64 v[238:239], 0
    v_mov_b64 v[240:241], 0
    v_mov_b64 v[242:243], 0
    v_mov_b64 v[244:245], 0
    v_mov_b64 v[246:247], 0
    v_mov_b64 v[248:249], 0
    v_mov_b64 v[250:251], 0
    v_mov_b64 v[252:253], 0
    v_mov_b64 v[254:255], 0
    s_waitcnt vmcnt(5)
    v_mov_b32 v17, 10368
    v_mov_b32 v18, 1
    s_mov_b64 exec, 1
    ds_add_u32 v17, v18
    s_mov_b64 exec, -1
    s_cmp_eq_u32 s38, 0
    s_cbranch_scc1 tp_main_kernel_a_done
    s_waitcnt lgkmcnt(0)
    ds_read2_b32 v[50:51], v2 offset0:80 offset1:96
    ds_read_b128 v[56:59], v0 offset:0
    ds_read_b128 v[60:63], v0 offset:1024
    ds_read_b128 v[16:19], v5 offset:0
    ds_read_b128 v[20:23], v7 offset:0
    ds_read_b64_tr_b16 v[10:11], v1 offset:0
    ds_read_b64_tr_b16 v[12:13], v1 offset:256
    ds_read_b64_tr_b16 v[64:65], v1 offset:512
    ds_read_b64_tr_b16 v[66:67], v1 offset:768
    ds_read_b64 v[48:49], v3 offset:10752
tp_main_kernel_a_loop:
    s_setprio 3
    s_waitcnt lgkmcnt(1)
    v_mfma_f32_32x32x16_bf16 v[32:47], v[16:19], v[56:59], 0
    v_mad_u32_u16 v50, v50, s78, v14 op_sel:[1,0,0,0]
    s_add_u32 m0, s33, 5120
    v_mad_u32_u16 v51, v51, s78, v14 op_sel:[1,0,0,0]
    buffer_load_dwordx4 v50, s[4:7], s80 offen lds
    s_cmp_ge_i32 s39, 3
    s_cselect_b32 s80, s68, s69
    s_add_u32 m0, s33, 0
    v_mfma_f32_32x32x16_bf16 v[32:47], v[20:23], v[60:63], v[32:47]
    buffer_load_dwordx4 v51, s[4:7], s80 offen lds
    s_nop 3
    s_waitcnt vmcnt(5) lgkmcnt(0)
    v_perm_b32 v8, v49, v48, v6
    v_mfma_f32_32x32x16_bf16 v[48:63], v[16:19], v[24:27], 0
    s_lshl_b64 s[40:41], s[44:45], 2
    s_lshl_b64 s[42:43], s[46:47], 2
    ds_read_b64_tr_b16 v[16:17], v1 offset:1024
    ds_read_b64_tr_b16 v[18:19], v1 offset:1280
    v_mul_f32 v32, v32, v10
    v_mul_f32 v33, v33, v11
    v_mul_f32 v34, v34, v12
    v_mul_f32 v35, v35, v13
    v_mfma_f32_32x32x16_bf16 v[48:63], v[20:23], v[28:31], v[48:63]
    ds_read_b64_tr_b16 v[20:21], v1 offset:1536
    ds_read_b64_tr_b16 v[22:23], v1 offset:1792
    v_mul_f32 v36, v36, v64
    v_mul_f32 v37, v37, v65
    v_mul_f32 v38, v38, v66
    v_mul_f32 v39, v39, v67
    v_cvt_pk_bf16_f32 v33, v32, v33
    v_cvt_pk_bf16_f32 v35, v34, v35
    v_cvt_pk_bf16_f32 v37, v36, v37
    v_cvt_pk_bf16_f32 v39, v38, v39
    s_waitcnt lgkmcnt(2)
    v_mul_f32 v40, v40, v16
    v_mul_f32 v41, v41, v17
    v_mul_f32 v42, v42, v18
    v_mul_f32 v43, v43, v19
    v_mul_f32 v48, v48, v10
    v_mul_f32 v49, v49, v11
    v_mul_f32 v50, v50, v12
    v_mul_f32 v51, v51, v13
    v_mul_f32 v52, v52, v64
    v_mul_f32 v53, v53, v65
    v_mul_f32 v54, v54, v66
    v_mul_f32 v55, v55, v67
    s_waitcnt lgkmcnt(0)
    s_buffer_load_dwordx4 s[44:47], s[88:91], s92
    s_add_u32 s92, s92, 16
    v_cvt_pk_bf16_f32 v32, v48, v49
    v_cvt_pk_bf16_f32 v34, v50, v51
    v_cvt_pk_bf16_f32 v36, v52, v53
    v_cvt_pk_bf16_f32 v38, v54, v55
    v_mul_f32 v44, v44, v20
    v_mul_f32 v45, v45, v21
    v_mul_f32 v46, v46, v22
    v_mul_f32 v47, v47, v23
    v_mul_f32 v56, v56, v16
    v_mul_f32 v57, v57, v17
    v_mul_f32 v58, v58, v18
    v_mul_f32 v59, v59, v19
    v_cvt_pk_bf16_f32 v41, v40, v41
    v_cvt_pk_bf16_f32 v43, v42, v43
    v_cvt_pk_bf16_f32 v45, v44, v45
    v_cvt_pk_bf16_f32 v47, v46, v47
    v_mul_f32 v60, v60, v20
    v_mul_f32 v61, v61, v21
    v_mul_f32 v62, v62, v22
    v_mul_f32 v63, v63, v23
    v_cvt_pk_bf16_f32 v40, v56, v57
    v_cvt_pk_bf16_f32 v42, v58, v59
    v_cvt_pk_bf16_f32 v44, v60, v61
    v_cvt_pk_bf16_f32 v46, v62, v63
    s_set_gpr_idx_on s40, 0xc
    ds_read_b32 v53, v4 offset:40768
    v_mfma_f32_4x4x4_16b_bf16 v[156:159], v[8:9], v[32:33], v[156:159] cbsz:4 abid:0
    s_set_gpr_idx_on s41, 0xc
    s_lshr_b64 s[40:41], s[40:41], 8
    ds_read2_b32 v[50:51], v2 offset0:112 offset1:128
    v_mfma_f32_4x4x4_16b_bf16 v[156:159], v[8:9], v[32:33], v[156:159] cbsz:4 abid:1
    s_set_gpr_idx_on s40, 0xc
    ds_read_b128 v[56:59], v0 offset:0
    v_mfma_f32_4x4x4_16b_bf16 v[156:159], v[8:9], v[34:35], v[156:159] cbsz:4 abid:2
    s_set_gpr_idx_on s41, 0xc
    s_lshr_b64 s[40:41], s[40:41], 8
    v_mfma_f32_4x4x4_16b_bf16 v[156:159], v[8:9], v[34:35], v[156:159] cbsz:4 abid:3
    s_set_gpr_idx_on s40, 0xc
    ds_read_b128 v[60:63], v0 offset:1024
    v_mfma_f32_4x4x4_16b_bf16 v[156:159], v[8:9], v[36:37], v[156:159] cbsz:4 abid:4
    s_set_gpr_idx_on s41, 0xc
    s_lshr_b64 s[40:41], s[40:41], 8
    v_mfma_f32_4x4x4_16b_bf16 v[156:159], v[8:9], v[36:37], v[156:159] cbsz:4 abid:5
    s_set_gpr_idx_on s40, 0xc
    ds_read_b128 v[16:19], v5 offset:512
    v_mfma_f32_4x4x4_16b_bf16 v[156:159], v[8:9], v[38:39], v[156:159] cbsz:4 abid:6
    s_set_gpr_idx_on s41, 0xc
    ds_read_b128 v[20:23], v7 offset:512
    v_mfma_f32_4x4x4_16b_bf16 v[156:159], v[8:9], v[38:39], v[156:159] cbsz:4 abid:7
    s_set_gpr_idx_on s42, 0xc
    ds_read_b64_tr_b16 v[10:11], v1 offset:2048
    v_mfma_f32_4x4x4_16b_bf16 v[156:159], v[8:9], v[40:41], v[156:159] cbsz:4 abid:8
    s_set_gpr_idx_on s43, 0xc
    s_lshr_b64 s[42:43], s[42:43], 8
    v_mfma_f32_4x4x4_16b_bf16 v[156:159], v[8:9], v[40:41], v[156:159] cbsz:4 abid:9
    s_set_gpr_idx_on s42, 0xc
    ds_read_b64_tr_b16 v[12:13], v1 offset:2304
    v_mfma_f32_4x4x4_16b_bf16 v[156:159], v[8:9], v[42:43], v[156:159] cbsz:4 abid:10
    s_set_gpr_idx_on s43, 0xc
    s_lshr_b64 s[42:43], s[42:43], 8
    v_mfma_f32_4x4x4_16b_bf16 v[156:159], v[8:9], v[42:43], v[156:159] cbsz:4 abid:11
    s_set_gpr_idx_on s42, 0xc
    ds_read_b64_tr_b16 v[64:65], v1 offset:2560
    v_mfma_f32_4x4x4_16b_bf16 v[156:159], v[8:9], v[44:45], v[156:159] cbsz:4 abid:12
    s_set_gpr_idx_on s43, 0xc
    s_lshr_b64 s[42:43], s[42:43], 8
    v_mfma_f32_4x4x4_16b_bf16 v[156:159], v[8:9], v[44:45], v[156:159] cbsz:4 abid:13
    s_set_gpr_idx_on s42, 0xc
    ds_read_b64_tr_b16 v[66:67], v1 offset:2816
    v_mfma_f32_4x4x4_16b_bf16 v[156:159], v[8:9], v[46:47], v[156:159] cbsz:4 abid:14
    s_set_gpr_idx_on s43, 0xc
    ds_read_b64 v[48:49], v3 offset:10880
    v_mfma_f32_4x4x4_16b_bf16 v[156:159], v[8:9], v[46:47], v[156:159] cbsz:4 abid:15
    s_set_gpr_idx_off
    s_sub_u32 s39, s39, 1
    s_cbranch_scc1 tp_main_kernel_a_done
    s_waitcnt lgkmcnt(1)
    v_mfma_f32_32x32x16_bf16 v[32:47], v[16:19], v[56:59], 0
    v_mad_u32_u16 v50, v50, s78, v14 op_sel:[1,0,0,0]
    s_add_u32 m0, s33, 1024
    v_mad_u32_u16 v51, v51, s78, v14 op_sel:[1,0,0,0]
    buffer_load_dwordx4 v50, s[4:7], s80 offen lds
    s_cmp_ge_i32 s39, 3
    s_cselect_b32 s80, s68, s69
    s_add_u32 m0, s33, 2048
    v_mfma_f32_32x32x16_bf16 v[32:47], v[20:23], v[60:63], v[32:47]
    buffer_load_dwordx4 v51, s[4:7], s80 offen lds
    s_add_u32 m0, s33, 6144
    v_bfi_b32 v53, 31, v0, v53
    buffer_load_dwordx4 v53, s[8:11], s80 offen lds
    s_nop 0
    s_waitcnt vmcnt(5) lgkmcnt(0)
    v_perm_b32 v8, v49, v48, v6
    v_mfma_f32_32x32x16_bf16 v[48:63], v[16:19], v[24:27], 0
    s_lshl_b64 s[40:41], s[44:45], 2
    s_lshl_b64 s[42:43], s[46:47], 2
    ds_read_b64_tr_b16 v[16:17], v1 offset:3072
    ds_read_b64_tr_b16 v[18:19], v1 offset:3328
    v_mul_f32 v32, v32, v10
    v_mul_f32 v33, v33, v11
    v_mul_f32 v34, v34, v12
    v_mul_f32 v35, v35, v13
    v_mfma_f32_32x32x16_bf16 v[48:63], v[20:23], v[28:31], v[48:63]
    ds_read_b64_tr_b16 v[20:21], v1 offset:3584
    ds_read_b64_tr_b16 v[22:23], v1 offset:3840
    v_mul_f32 v36, v36, v64
    v_mul_f32 v37, v37, v65
    v_mul_f32 v38, v38, v66
    v_mul_f32 v39, v39, v67
    v_cvt_pk_bf16_f32 v33, v32, v33
    v_cvt_pk_bf16_f32 v35, v34, v35
    v_cvt_pk_bf16_f32 v37, v36, v37
    v_cvt_pk_bf16_f32 v39, v38, v39
    s_waitcnt lgkmcnt(2)
    v_mul_f32 v40, v40, v16
    v_mul_f32 v41, v41, v17
    v_mul_f32 v42, v42, v18
    v_mul_f32 v43, v43, v19
    v_mul_f32 v48, v48, v10
    v_mul_f32 v49, v49, v11
    v_mul_f32 v50, v50, v12
    v_mul_f32 v51, v51, v13
    v_mul_f32 v52, v52, v64
    v_mul_f32 v53, v53, v65
    v_mul_f32 v54, v54, v66
    v_mul_f32 v55, v55, v67
    s_waitcnt lgkmcnt(0)
    s_buffer_load_dwordx4 s[44:47], s[88:91], s92
    s_add_u32 s92, s92, 16
    v_cvt_pk_bf16_f32 v32, v48, v49
    v_cvt_pk_bf16_f32 v34, v50, v51
    v_cvt_pk_bf16_f32 v36, v52, v53
    v_cvt_pk_bf16_f32 v38, v54, v55
    v_mul_f32 v44, v44, v20
    v_mul_f32 v45, v45, v21
    v_mul_f32 v46, v46, v22
    v_mul_f32 v47, v47, v23
    v_mul_f32 v56, v56, v16
    v_mul_f32 v57, v57, v17
    v_mul_f32 v58, v58, v18
    v_mul_f32 v59, v59, v19
    v_cvt_pk_bf16_f32 v41, v40, v41
    v_cvt_pk_bf16_f32 v43, v42, v43
    v_cvt_pk_bf16_f32 v45, v44, v45
    v_cvt_pk_bf16_f32 v47, v46, v47
    v_mul_f32 v60, v60, v20
    v_mul_f32 v61, v61, v21
    v_mul_f32 v62, v62, v22
    v_mul_f32 v63, v63, v23
    v_cvt_pk_bf16_f32 v40, v56, v57
    v_cvt_pk_bf16_f32 v42, v58, v59
    v_cvt_pk_bf16_f32 v44, v60, v61
    v_cvt_pk_bf16_f32 v46, v62, v63
    s_set_gpr_idx_on s40, 0xc
    ds_read2_b32 v[50:51], v2 offset0:144 offset1:160
    v_mfma_f32_4x4x4_16b_bf16 v[156:159], v[8:9], v[32:33], v[156:159] cbsz:4 abid:0
    s_set_gpr_idx_on s41, 0xc
    s_lshr_b64 s[40:41], s[40:41], 8
    v_mfma_f32_4x4x4_16b_bf16 v[156:159], v[8:9], v[32:33], v[156:159] cbsz:4 abid:1
    s_set_gpr_idx_on s40, 0xc
    ds_read_b128 v[56:59], v0 offset:0
    v_mfma_f32_4x4x4_16b_bf16 v[156:159], v[8:9], v[34:35], v[156:159] cbsz:4 abid:2
    s_set_gpr_idx_on s41, 0xc
    s_lshr_b64 s[40:41], s[40:41], 8
    v_mfma_f32_4x4x4_16b_bf16 v[156:159], v[8:9], v[34:35], v[156:159] cbsz:4 abid:3
    s_set_gpr_idx_on s40, 0xc
    ds_read_b128 v[60:63], v0 offset:1024
    v_mfma_f32_4x4x4_16b_bf16 v[156:159], v[8:9], v[36:37], v[156:159] cbsz:4 abid:4
    s_set_gpr_idx_on s41, 0xc
    s_lshr_b64 s[40:41], s[40:41], 8
    v_mfma_f32_4x4x4_16b_bf16 v[156:159], v[8:9], v[36:37], v[156:159] cbsz:4 abid:5
    s_set_gpr_idx_on s40, 0xc
    ds_read_b128 v[16:19], v5 offset:1024
    v_mfma_f32_4x4x4_16b_bf16 v[156:159], v[8:9], v[38:39], v[156:159] cbsz:4 abid:6
    s_set_gpr_idx_on s41, 0xc
    ds_read_b128 v[20:23], v7 offset:1024
    v_mfma_f32_4x4x4_16b_bf16 v[156:159], v[8:9], v[38:39], v[156:159] cbsz:4 abid:7
    s_set_gpr_idx_on s42, 0xc
    ds_read_b64_tr_b16 v[10:11], v1 offset:4096
    v_mfma_f32_4x4x4_16b_bf16 v[156:159], v[8:9], v[40:41], v[156:159] cbsz:4 abid:8
    s_set_gpr_idx_on s43, 0xc
    s_lshr_b64 s[42:43], s[42:43], 8
    v_mfma_f32_4x4x4_16b_bf16 v[156:159], v[8:9], v[40:41], v[156:159] cbsz:4 abid:9
    s_set_gpr_idx_on s42, 0xc
    ds_read_b64_tr_b16 v[12:13], v1 offset:4352
    v_mfma_f32_4x4x4_16b_bf16 v[156:159], v[8:9], v[42:43], v[156:159] cbsz:4 abid:10
    s_set_gpr_idx_on s43, 0xc
    s_lshr_b64 s[42:43], s[42:43], 8
    v_mfma_f32_4x4x4_16b_bf16 v[156:159], v[8:9], v[42:43], v[156:159] cbsz:4 abid:11
    s_set_gpr_idx_on s42, 0xc
    ds_read_b64_tr_b16 v[64:65], v1 offset:4608
    v_mfma_f32_4x4x4_16b_bf16 v[156:159], v[8:9], v[44:45], v[156:159] cbsz:4 abid:12
    s_set_gpr_idx_on s43, 0xc
    s_lshr_b64 s[42:43], s[42:43], 8
    v_mfma_f32_4x4x4_16b_bf16 v[156:159], v[8:9], v[44:45], v[156:159] cbsz:4 abid:13
    s_set_gpr_idx_on s42, 0xc
    ds_read_b64_tr_b16 v[66:67], v1 offset:4864
    v_mfma_f32_4x4x4_16b_bf16 v[156:159], v[8:9], v[46:47], v[156:159] cbsz:4 abid:14
    s_set_gpr_idx_on s43, 0xc
    ds_read_b64 v[48:49], v3 offset:11008
    v_mfma_f32_4x4x4_16b_bf16 v[156:159], v[8:9], v[46:47], v[156:159] cbsz:4 abid:15
    s_set_gpr_idx_off
    s_sub_u32 s39, s39, 1
    s_cbranch_scc1 tp_main_kernel_a_done
    s_setprio 2
    s_cmp_lt_u32 s3, 4
    s_cbranch_scc1 1
    s_setprio 3
    s_waitcnt lgkmcnt(1)
    v_mfma_f32_32x32x16_bf16 v[32:47], v[16:19], v[56:59], 0
    v_mad_u32_u16 v50, v50, s78, v14 op_sel:[1,0,0,0]
    s_add_u32 m0, s33, 3072
    v_mad_u32_u16 v51, v51, s78, v14 op_sel:[1,0,0,0]
    buffer_load_dwordx4 v50, s[4:7], s80 offen lds
    s_cmp_ge_i32 s39, 3
    s_cselect_b32 s80, s68, s69
    s_add_u32 m0, s33, 4096
    v_mfma_f32_32x32x16_bf16 v[32:47], v[20:23], v[60:63], v[32:47]
    buffer_load_dwordx4 v51, s[4:7], s80 offen lds
    v_add_u32 v2, 512, v2
    v_add_u32 v3, 512, v3
    v_add_u32 v4, 256, v4
    s_nop 0
    s_waitcnt vmcnt(5) lgkmcnt(0)
    v_perm_b32 v8, v49, v48, v6
    v_mfma_f32_32x32x16_bf16 v[48:63], v[16:19], v[24:27], 0
    s_lshl_b64 s[40:41], s[44:45], 2
    s_lshl_b64 s[42:43], s[46:47], 2
    ds_read_b64_tr_b16 v[16:17], v1 offset:5120
    ds_read_b64_tr_b16 v[18:19], v1 offset:5376
    v_mul_f32 v32, v32, v10
    v_mul_f32 v33, v33, v11
    v_mul_f32 v34, v34, v12
    v_mul_f32 v35, v35, v13
    v_mfma_f32_32x32x16_bf16 v[48:63], v[20:23], v[28:31], v[48:63]
    ds_read_b64_tr_b16 v[20:21], v1 offset:5632
    ds_read_b64_tr_b16 v[22:23], v1 offset:5888
    v_mul_f32 v36, v36, v64
    v_mul_f32 v37, v37, v65
    v_mul_f32 v38, v38, v66
    v_mul_f32 v39, v39, v67
    v_cvt_pk_bf16_f32 v33, v32, v33
    v_cvt_pk_bf16_f32 v35, v34, v35
    v_cvt_pk_bf16_f32 v37, v36, v37
    v_cvt_pk_bf16_f32 v39, v38, v39
    s_waitcnt lgkmcnt(2)
    v_mul_f32 v40, v40, v16
    v_mul_f32 v41, v41, v17
    v_mul_f32 v42, v42, v18
    v_mul_f32 v43, v43, v19
    v_mul_f32 v48, v48, v10
    v_mul_f32 v49, v49, v11
    v_mul_f32 v50, v50, v12
    v_mul_f32 v51, v51, v13
    v_mul_f32 v52, v52, v64
    v_mul_f32 v53, v53, v65
    v_mul_f32 v54, v54, v66
    v_mul_f32 v55, v55, v67
    s_waitcnt lgkmcnt(0)
    s_buffer_load_dwordx4 s[44:47], s[88:91], s92
    s_add_u32 s92, s92, 16
    v_cvt_pk_bf16_f32 v32, v48, v49
    v_cvt_pk_bf16_f32 v34, v50, v51
    v_cvt_pk_bf16_f32 v36, v52, v53
    v_cvt_pk_bf16_f32 v38, v54, v55
    v_mul_f32 v44, v44, v20
    v_mul_f32 v45, v45, v21
    v_mul_f32 v46, v46, v22
    v_mul_f32 v47, v47, v23
    v_mul_f32 v56, v56, v16
    v_mul_f32 v57, v57, v17
    v_mul_f32 v58, v58, v18
    v_mul_f32 v59, v59, v19
    v_cvt_pk_bf16_f32 v41, v40, v41
    v_cvt_pk_bf16_f32 v43, v42, v43
    v_cvt_pk_bf16_f32 v45, v44, v45
    v_cvt_pk_bf16_f32 v47, v46, v47
    v_mul_f32 v60, v60, v20
    v_mul_f32 v61, v61, v21
    v_mul_f32 v62, v62, v22
    v_mul_f32 v63, v63, v23
    v_cvt_pk_bf16_f32 v40, v56, v57
    v_cvt_pk_bf16_f32 v42, v58, v59
    v_cvt_pk_bf16_f32 v44, v60, v61
    v_cvt_pk_bf16_f32 v46, v62, v63
    s_set_gpr_idx_on s40, 0xc
    ds_read_b32 v53, v4 offset:40640
    v_mfma_f32_4x4x4_16b_bf16 v[156:159], v[8:9], v[32:33], v[156:159] cbsz:4 abid:0
    s_set_gpr_idx_on s41, 0xc
    s_lshr_b64 s[40:41], s[40:41], 8
    ds_read2_b32 v[50:51], v2 offset0:48 offset1:64
    v_mfma_f32_4x4x4_16b_bf16 v[156:159], v[8:9], v[32:33], v[156:159] cbsz:4 abid:1
    s_set_gpr_idx_on s40, 0xc
    ds_read_b128 v[56:59], v0 offset:0
    v_mfma_f32_4x4x4_16b_bf16 v[156:159], v[8:9], v[34:35], v[156:159] cbsz:4 abid:2
    s_set_gpr_idx_on s41, 0xc
    s_lshr_b64 s[40:41], s[40:41], 8
    v_mfma_f32_4x4x4_16b_bf16 v[156:159], v[8:9], v[34:35], v[156:159] cbsz:4 abid:3
    s_set_gpr_idx_on s40, 0xc
    ds_read_b128 v[60:63], v0 offset:1024
    v_mfma_f32_4x4x4_16b_bf16 v[156:159], v[8:9], v[36:37], v[156:159] cbsz:4 abid:4
    s_set_gpr_idx_on s41, 0xc
    s_lshr_b64 s[40:41], s[40:41], 8
    v_mfma_f32_4x4x4_16b_bf16 v[156:159], v[8:9], v[36:37], v[156:159] cbsz:4 abid:5
    s_set_gpr_idx_on s40, 0xc
    ds_read_b128 v[16:19], v5 offset:1536
    v_mfma_f32_4x4x4_16b_bf16 v[156:159], v[8:9], v[38:39], v[156:159] cbsz:4 abid:6
    s_set_gpr_idx_on s41, 0xc
    ds_read_b128 v[20:23], v7 offset:1536
    v_mfma_f32_4x4x4_16b_bf16 v[156:159], v[8:9], v[38:39], v[156:159] cbsz:4 abid:7
    s_set_gpr_idx_on s42, 0xc
    ds_read_b64_tr_b16 v[10:11], v1 offset:0
    v_mfma_f32_4x4x4_16b_bf16 v[156:159], v[8:9], v[40:41], v[156:159] cbsz:4 abid:8
    s_set_gpr_idx_on s43, 0xc
    s_lshr_b64 s[42:43], s[42:43], 8
    v_mfma_f32_4x4x4_16b_bf16 v[156:159], v[8:9], v[40:41], v[156:159] cbsz:4 abid:9
    s_set_gpr_idx_on s42, 0xc
    ds_read_b64_tr_b16 v[12:13], v1 offset:256
    v_mfma_f32_4x4x4_16b_bf16 v[156:159], v[8:9], v[42:43], v[156:159] cbsz:4 abid:10
    s_set_gpr_idx_on s43, 0xc
    s_lshr_b64 s[42:43], s[42:43], 8
    v_mfma_f32_4x4x4_16b_bf16 v[156:159], v[8:9], v[42:43], v[156:159] cbsz:4 abid:11
    s_set_gpr_idx_on s42, 0xc
    ds_read_b64_tr_b16 v[64:65], v1 offset:512
    v_mfma_f32_4x4x4_16b_bf16 v[156:159], v[8:9], v[44:45], v[156:159] cbsz:4 abid:12
    s_set_gpr_idx_on s43, 0xc
    s_lshr_b64 s[42:43], s[42:43], 8
    v_mfma_f32_4x4x4_16b_bf16 v[156:159], v[8:9], v[44:45], v[156:159] cbsz:4 abid:13
    s_set_gpr_idx_on s42, 0xc
    ds_read_b64_tr_b16 v[66:67], v1 offset:768
    v_mfma_f32_4x4x4_16b_bf16 v[156:159], v[8:9], v[46:47], v[156:159] cbsz:4 abid:14
    s_set_gpr_idx_on s43, 0xc
    ds_read_b64 v[48:49], v3 offset:10624
    v_mfma_f32_4x4x4_16b_bf16 v[156:159], v[8:9], v[46:47], v[156:159] cbsz:4 abid:15
    s_set_gpr_idx_off
    s_sub_u32 s39, s39, 1
    s_cbranch_scc1 tp_main_kernel_a_done
    s_setprio 3
    s_waitcnt lgkmcnt(1)
    v_mfma_f32_32x32x16_bf16 v[32:47], v[16:19], v[56:59], 0
    v_mad_u32_u16 v50, v50, s78, v14 op_sel:[1,0,0,0]
    s_add_u32 m0, s33, 5120
    v_mad_u32_u16 v51, v51, s78, v14 op_sel:[1,0,0,0]
    buffer_load_dwordx4 v50, s[4:7], s80 offen lds
    s_cmp_ge_i32 s39, 3
    s_cselect_b32 s80, s68, s69
    s_add_u32 m0, s33, 0
    v_mfma_f32_32x32x16_bf16 v[32:47], v[20:23], v[60:63], v[32:47]
    buffer_load_dwordx4 v51, s[4:7], s80 offen lds
    s_add_u32 m0, s33, 7168
    v_bfi_b32 v53, 31, v0, v53
    buffer_load_dwordx4 v53, s[8:11], s80 offen lds
    s_nop 0
    s_waitcnt vmcnt(5) lgkmcnt(0)
    v_perm_b32 v8, v49, v48, v6
    v_mfma_f32_32x32x16_bf16 v[48:63], v[16:19], v[24:27], 0
    s_lshl_b64 s[40:41], s[44:45], 2
    s_lshl_b64 s[42:43], s[46:47], 2
    ds_read_b64_tr_b16 v[16:17], v1 offset:1024
    ds_read_b64_tr_b16 v[18:19], v1 offset:1280
    v_mul_f32 v32, v32, v10
    v_mul_f32 v33, v33, v11
    v_mul_f32 v34, v34, v12
    v_mul_f32 v35, v35, v13
    v_mfma_f32_32x32x16_bf16 v[48:63], v[20:23], v[28:31], v[48:63]
    ds_read_b64_tr_b16 v[20:21], v1 offset:1536
    ds_read_b64_tr_b16 v[22:23], v1 offset:1792
    v_mul_f32 v36, v36, v64
    v_mul_f32 v37, v37, v65
    v_mul_f32 v38, v38, v66
    v_mul_f32 v39, v39, v67
    v_cvt_pk_bf16_f32 v33, v32, v33
    v_cvt_pk_bf16_f32 v35, v34, v35
    v_cvt_pk_bf16_f32 v37, v36, v37
    v_cvt_pk_bf16_f32 v39, v38, v39
    s_waitcnt lgkmcnt(2)
    v_mul_f32 v40, v40, v16
    v_mul_f32 v41, v41, v17
    v_mul_f32 v42, v42, v18
    v_mul_f32 v43, v43, v19
    v_mul_f32 v48, v48, v10
    v_mul_f32 v49, v49, v11
    v_mul_f32 v50, v50, v12
    v_mul_f32 v51, v51, v13
    v_mul_f32 v52, v52, v64
    v_mul_f32 v53, v53, v65
    v_mul_f32 v54, v54, v66
    v_mul_f32 v55, v55, v67
    s_waitcnt lgkmcnt(0)
    s_buffer_load_dwordx4 s[44:47], s[88:91], s92
    s_add_u32 s92, s92, 16
    v_cvt_pk_bf16_f32 v32, v48, v49
    v_cvt_pk_bf16_f32 v34, v50, v51
    v_cvt_pk_bf16_f32 v36, v52, v53
    v_cvt_pk_bf16_f32 v38, v54, v55
    v_mul_f32 v44, v44, v20
    v_mul_f32 v45, v45, v21
    v_mul_f32 v46, v46, v22
    v_mul_f32 v47, v47, v23
    v_mul_f32 v56, v56, v16
    v_mul_f32 v57, v57, v17
    v_mul_f32 v58, v58, v18
    v_mul_f32 v59, v59, v19
    v_cvt_pk_bf16_f32 v41, v40, v41
    v_cvt_pk_bf16_f32 v43, v42, v43
    v_cvt_pk_bf16_f32 v45, v44, v45
    v_cvt_pk_bf16_f32 v47, v46, v47
    v_mul_f32 v60, v60, v20
    v_mul_f32 v61, v61, v21
    v_mul_f32 v62, v62, v22
    v_mul_f32 v63, v63, v23
    v_cvt_pk_bf16_f32 v40, v56, v57
    v_cvt_pk_bf16_f32 v42, v58, v59
    v_cvt_pk_bf16_f32 v44, v60, v61
    v_cvt_pk_bf16_f32 v46, v62, v63
    s_set_gpr_idx_on s40, 0xc
    ds_read2_b32 v[50:51], v2 offset0:80 offset1:96
    v_mfma_f32_4x4x4_16b_bf16 v[156:159], v[8:9], v[32:33], v[156:159] cbsz:4 abid:0
    s_set_gpr_idx_on s41, 0xc
    s_lshr_b64 s[40:41], s[40:41], 8
    v_mfma_f32_4x4x4_16b_bf16 v[156:159], v[8:9], v[32:33], v[156:159] cbsz:4 abid:1
    s_set_gpr_idx_on s40, 0xc
    ds_read_b128 v[56:59], v0 offset:0
    v_mfma_f32_4x4x4_16b_bf16 v[156:159], v[8:9], v[34:35], v[156:159] cbsz:4 abid:2
    s_set_gpr_idx_on s41, 0xc
    s_lshr_b64 s[40:41], s[40:41], 8
    v_mfma_f32_4x4x4_16b_bf16 v[156:159], v[8:9], v[34:35], v[156:159] cbsz:4 abid:3
    s_set_gpr_idx_on s40, 0xc
    ds_read_b128 v[60:63], v0 offset:1024
    v_mfma_f32_4x4x4_16b_bf16 v[156:159], v[8:9], v[36:37], v[156:159] cbsz:4 abid:4
    s_set_gpr_idx_on s41, 0xc
    s_lshr_b64 s[40:41], s[40:41], 8
    v_mfma_f32_4x4x4_16b_bf16 v[156:159], v[8:9], v[36:37], v[156:159] cbsz:4 abid:5
    s_set_gpr_idx_on s40, 0xc
    ds_read_b128 v[16:19], v5 offset:0
    v_mfma_f32_4x4x4_16b_bf16 v[156:159], v[8:9], v[38:39], v[156:159] cbsz:4 abid:6
    s_set_gpr_idx_on s41, 0xc
    ds_read_b128 v[20:23], v7 offset:0
    v_mfma_f32_4x4x4_16b_bf16 v[156:159], v[8:9], v[38:39], v[156:159] cbsz:4 abid:7
    s_set_gpr_idx_on s42, 0xc
    ds_read_b64_tr_b16 v[10:11], v1 offset:2048
    v_mfma_f32_4x4x4_16b_bf16 v[156:159], v[8:9], v[40:41], v[156:159] cbsz:4 abid:8
    s_set_gpr_idx_on s43, 0xc
    s_lshr_b64 s[42:43], s[42:43], 8
    v_mfma_f32_4x4x4_16b_bf16 v[156:159], v[8:9], v[40:41], v[156:159] cbsz:4 abid:9
    s_set_gpr_idx_on s42, 0xc
    ds_read_b64_tr_b16 v[12:13], v1 offset:2304
    v_mfma_f32_4x4x4_16b_bf16 v[156:159], v[8:9], v[42:43], v[156:159] cbsz:4 abid:10
    s_set_gpr_idx_on s43, 0xc
    s_lshr_b64 s[42:43], s[42:43], 8
    v_mfma_f32_4x4x4_16b_bf16 v[156:159], v[8:9], v[42:43], v[156:159] cbsz:4 abid:11
    s_set_gpr_idx_on s42, 0xc
    ds_read_b64_tr_b16 v[64:65], v1 offset:2560
    v_mfma_f32_4x4x4_16b_bf16 v[156:159], v[8:9], v[44:45], v[156:159] cbsz:4 abid:12
    s_set_gpr_idx_on s43, 0xc
    s_lshr_b64 s[42:43], s[42:43], 8
    v_mfma_f32_4x4x4_16b_bf16 v[156:159], v[8:9], v[44:45], v[156:159] cbsz:4 abid:13
    s_set_gpr_idx_on s42, 0xc
    ds_read_b64_tr_b16 v[66:67], v1 offset:2816
    v_mfma_f32_4x4x4_16b_bf16 v[156:159], v[8:9], v[46:47], v[156:159] cbsz:4 abid:14
    s_set_gpr_idx_on s43, 0xc
    ds_read_b64 v[48:49], v3 offset:10752
    v_mfma_f32_4x4x4_16b_bf16 v[156:159], v[8:9], v[46:47], v[156:159] cbsz:4 abid:15
    s_set_gpr_idx_off
    s_sub_u32 s39, s39, 1
    s_cbranch_scc1 tp_main_kernel_a_done
    s_waitcnt lgkmcnt(1)
    v_mfma_f32_32x32x16_bf16 v[32:47], v[16:19], v[56:59], 0
    v_mad_u32_u16 v50, v50, s78, v14 op_sel:[1,0,0,0]
    s_add_u32 m0, s33, 1024
    v_mad_u32_u16 v51, v51, s78, v14 op_sel:[1,0,0,0]
    buffer_load_dwordx4 v50, s[4:7], s80 offen lds
    s_cmp_ge_i32 s39, 3
    s_cselect_b32 s80, s68, s69
    s_add_u32 m0, s33, 2048
    v_mfma_f32_32x32x16_bf16 v[32:47], v[20:23], v[60:63], v[32:47]
    buffer_load_dwordx4 v51, s[4:7], s80 offen lds
    s_nop 3
    s_waitcnt vmcnt(5) lgkmcnt(0)
    v_perm_b32 v8, v49, v48, v6
    v_mfma_f32_32x32x16_bf16 v[48:63], v[16:19], v[24:27], 0
    s_lshl_b64 s[40:41], s[44:45], 2
    s_lshl_b64 s[42:43], s[46:47], 2
    ds_read_b64_tr_b16 v[16:17], v1 offset:3072
    ds_read_b64_tr_b16 v[18:19], v1 offset:3328
    v_mul_f32 v32, v32, v10
    v_mul_f32 v33, v33, v11
    v_mul_f32 v34, v34, v12
    v_mul_f32 v35, v35, v13
    v_mfma_f32_32x32x16_bf16 v[48:63], v[20:23], v[28:31], v[48:63]
    ds_read_b64_tr_b16 v[20:21], v1 offset:3584
    ds_read_b64_tr_b16 v[22:23], v1 offset:3840
    v_mul_f32 v36, v36, v64
    v_mul_f32 v37, v37, v65
    v_mul_f32 v38, v38, v66
    v_mul_f32 v39, v39, v67
    v_cvt_pk_bf16_f32 v33, v32, v33
    v_cvt_pk_bf16_f32 v35, v34, v35
    v_cvt_pk_bf16_f32 v37, v36, v37
    v_cvt_pk_bf16_f32 v39, v38, v39
    s_waitcnt lgkmcnt(2)
    v_mul_f32 v40, v40, v16
    v_mul_f32 v41, v41, v17
    v_mul_f32 v42, v42, v18
    v_mul_f32 v43, v43, v19
    v_mul_f32 v48, v48, v10
    v_mul_f32 v49, v49, v11
    v_mul_f32 v50, v50, v12
    v_mul_f32 v51, v51, v13
    v_mul_f32 v52, v52, v64
    v_mul_f32 v53, v53, v65
    v_mul_f32 v54, v54, v66
    v_mul_f32 v55, v55, v67
    s_waitcnt lgkmcnt(0)
    s_buffer_load_dwordx4 s[44:47], s[88:91], s92
    s_add_u32 s92, s92, 16
    v_cvt_pk_bf16_f32 v32, v48, v49
    v_cvt_pk_bf16_f32 v34, v50, v51
    v_cvt_pk_bf16_f32 v36, v52, v53
    v_cvt_pk_bf16_f32 v38, v54, v55
    v_mul_f32 v44, v44, v20
    v_mul_f32 v45, v45, v21
    v_mul_f32 v46, v46, v22
    v_mul_f32 v47, v47, v23
    v_mul_f32 v56, v56, v16
    v_mul_f32 v57, v57, v17
    v_mul_f32 v58, v58, v18
    v_mul_f32 v59, v59, v19
    v_cvt_pk_bf16_f32 v41, v40, v41
    v_cvt_pk_bf16_f32 v43, v42, v43
    v_cvt_pk_bf16_f32 v45, v44, v45
    v_cvt_pk_bf16_f32 v47, v46, v47
    v_mul_f32 v60, v60, v20
    v_mul_f32 v61, v61, v21
    v_mul_f32 v62, v62, v22
    v_mul_f32 v63, v63, v23
    v_cvt_pk_bf16_f32 v40, v56, v57
    v_cvt_pk_bf16_f32 v42, v58, v59
    v_cvt_pk_bf16_f32 v44, v60, v61
    v_cvt_pk_bf16_f32 v46, v62, v63
    s_set_gpr_idx_on s40, 0xc
    ds_read_b32 v53, v4 offset:40768
    v_mfma_f32_4x4x4_16b_bf16 v[156:159], v[8:9], v[32:33], v[156:159] cbsz:4 abid:0
    s_set_gpr_idx_on s41, 0xc
    s_lshr_b64 s[40:41], s[40:41], 8
    ds_read2_b32 v[50:51], v2 offset0:112 offset1:128
    v_mfma_f32_4x4x4_16b_bf16 v[156:159], v[8:9], v[32:33], v[156:159] cbsz:4 abid:1
    s_set_gpr_idx_on s40, 0xc
    ds_read_b128 v[56:59], v0 offset:0
    v_mfma_f32_4x4x4_16b_bf16 v[156:159], v[8:9], v[34:35], v[156:159] cbsz:4 abid:2
    s_set_gpr_idx_on s41, 0xc
    s_lshr_b64 s[40:41], s[40:41], 8
    v_mfma_f32_4x4x4_16b_bf16 v[156:159], v[8:9], v[34:35], v[156:159] cbsz:4 abid:3
    s_set_gpr_idx_on s40, 0xc
    ds_read_b128 v[60:63], v0 offset:1024
    v_mfma_f32_4x4x4_16b_bf16 v[156:159], v[8:9], v[36:37], v[156:159] cbsz:4 abid:4
    s_set_gpr_idx_on s41, 0xc
    s_lshr_b64 s[40:41], s[40:41], 8
    v_mfma_f32_4x4x4_16b_bf16 v[156:159], v[8:9], v[36:37], v[156:159] cbsz:4 abid:5
    s_set_gpr_idx_on s40, 0xc
    ds_read_b128 v[16:19], v5 offset:512
    v_mfma_f32_4x4x4_16b_bf16 v[156:159], v[8:9], v[38:39], v[156:159] cbsz:4 abid:6
    s_set_gpr_idx_on s41, 0xc
    ds_read_b128 v[20:23], v7 offset:512
    v_mfma_f32_4x4x4_16b_bf16 v[156:159], v[8:9], v[38:39], v[156:159] cbsz:4 abid:7
    s_set_gpr_idx_on s42, 0xc
    ds_read_b64_tr_b16 v[10:11], v1 offset:4096
    v_mfma_f32_4x4x4_16b_bf16 v[156:159], v[8:9], v[40:41], v[156:159] cbsz:4 abid:8
    s_set_gpr_idx_on s43, 0xc
    s_lshr_b64 s[42:43], s[42:43], 8
    v_mfma_f32_4x4x4_16b_bf16 v[156:159], v[8:9], v[40:41], v[156:159] cbsz:4 abid:9
    s_set_gpr_idx_on s42, 0xc
    ds_read_b64_tr_b16 v[12:13], v1 offset:4352
    v_mfma_f32_4x4x4_16b_bf16 v[156:159], v[8:9], v[42:43], v[156:159] cbsz:4 abid:10
    s_set_gpr_idx_on s43, 0xc
    s_lshr_b64 s[42:43], s[42:43], 8
    v_mfma_f32_4x4x4_16b_bf16 v[156:159], v[8:9], v[42:43], v[156:159] cbsz:4 abid:11
    s_set_gpr_idx_on s42, 0xc
    ds_read_b64_tr_b16 v[64:65], v1 offset:4608
    v_mfma_f32_4x4x4_16b_bf16 v[156:159], v[8:9], v[44:45], v[156:159] cbsz:4 abid:12
    s_set_gpr_idx_on s43, 0xc
    s_lshr_b64 s[42:43], s[42:43], 8
    v_mfma_f32_4x4x4_16b_bf16 v[156:159], v[8:9], v[44:45], v[156:159] cbsz:4 abid:13
    s_set_gpr_idx_on s42, 0xc
    ds_read_b64_tr_b16 v[66:67], v1 offset:4864
    v_mfma_f32_4x4x4_16b_bf16 v[156:159], v[8:9], v[46:47], v[156:159] cbsz:4 abid:14
    s_set_gpr_idx_on s43, 0xc
    ds_read_b64 v[48:49], v3 offset:10880
    v_mfma_f32_4x4x4_16b_bf16 v[156:159], v[8:9], v[46:47], v[156:159] cbsz:4 abid:15
    s_set_gpr_idx_off
    s_sub_u32 s39, s39, 1
    s_cbranch_scc1 tp_main_kernel_a_done
    s_setprio 2
    s_cmp_lt_u32 s3, 4
    s_cbranch_scc1 1
    s_setprio 3
    s_waitcnt lgkmcnt(1)
    v_mfma_f32_32x32x16_bf16 v[32:47], v[16:19], v[56:59], 0
    v_mad_u32_u16 v50, v50, s78, v14 op_sel:[1,0,0,0]
    s_add_u32 m0, s33, 3072
    v_mad_u32_u16 v51, v51, s78, v14 op_sel:[1,0,0,0]
    buffer_load_dwordx4 v50, s[4:7], s80 offen lds
    s_cmp_ge_i32 s39, 3
    s_cselect_b32 s80, s68, s69
    s_add_u32 m0, s33, 4096
    v_mfma_f32_32x32x16_bf16 v[32:47], v[20:23], v[60:63], v[32:47]
    buffer_load_dwordx4 v51, s[4:7], s80 offen lds
    s_add_u32 m0, s33, 6144
    v_bfi_b32 v53, 31, v0, v53
    buffer_load_dwordx4 v53, s[8:11], s80 offen lds
    s_nop 0
    s_waitcnt vmcnt(5) lgkmcnt(0)
    v_perm_b32 v8, v49, v48, v6
    v_mfma_f32_32x32x16_bf16 v[48:63], v[16:19], v[24:27], 0
    s_lshl_b64 s[40:41], s[44:45], 2
    s_lshl_b64 s[42:43], s[46:47], 2
    ds_read_b64_tr_b16 v[16:17], v1 offset:5120
    ds_read_b64_tr_b16 v[18:19], v1 offset:5376
    v_mul_f32 v32, v32, v10
    v_mul_f32 v33, v33, v11
    v_mul_f32 v34, v34, v12
    v_mul_f32 v35, v35, v13
    v_mfma_f32_32x32x16_bf16 v[48:63], v[20:23], v[28:31], v[48:63]
    ds_read_b64_tr_b16 v[20:21], v1 offset:5632
    ds_read_b64_tr_b16 v[22:23], v1 offset:5888
    v_mul_f32 v36, v36, v64
    v_mul_f32 v37, v37, v65
    v_mul_f32 v38, v38, v66
    v_mul_f32 v39, v39, v67
    v_cvt_pk_bf16_f32 v33, v32, v33
    v_cvt_pk_bf16_f32 v35, v34, v35
    v_cvt_pk_bf16_f32 v37, v36, v37
    v_cvt_pk_bf16_f32 v39, v38, v39
    s_waitcnt lgkmcnt(2)
    v_mul_f32 v40, v40, v16
    v_mul_f32 v41, v41, v17
    v_mul_f32 v42, v42, v18
    v_mul_f32 v43, v43, v19
    v_mul_f32 v48, v48, v10
    v_mul_f32 v49, v49, v11
    v_mul_f32 v50, v50, v12
    v_mul_f32 v51, v51, v13
    v_mul_f32 v52, v52, v64
    v_mul_f32 v53, v53, v65
    v_mul_f32 v54, v54, v66
    v_mul_f32 v55, v55, v67
    s_waitcnt lgkmcnt(0)
    s_buffer_load_dwordx4 s[44:47], s[88:91], s92
    s_add_u32 s92, s92, 16
    v_cvt_pk_bf16_f32 v32, v48, v49
    v_cvt_pk_bf16_f32 v34, v50, v51
    v_cvt_pk_bf16_f32 v36, v52, v53
    v_cvt_pk_bf16_f32 v38, v54, v55
    v_mul_f32 v44, v44, v20
    v_mul_f32 v45, v45, v21
    v_mul_f32 v46, v46, v22
    v_mul_f32 v47, v47, v23
    v_mul_f32 v56, v56, v16
    v_mul_f32 v57, v57, v17
    v_mul_f32 v58, v58, v18
    v_mul_f32 v59, v59, v19
    v_cvt_pk_bf16_f32 v41, v40, v41
    v_cvt_pk_bf16_f32 v43, v42, v43
    v_cvt_pk_bf16_f32 v45, v44, v45
    v_cvt_pk_bf16_f32 v47, v46, v47
    v_mul_f32 v60, v60, v20
    v_mul_f32 v61, v61, v21
    v_mul_f32 v62, v62, v22
    v_mul_f32 v63, v63, v23
    v_cvt_pk_bf16_f32 v40, v56, v57
    v_cvt_pk_bf16_f32 v42, v58, v59
    v_cvt_pk_bf16_f32 v44, v60, v61
    v_cvt_pk_bf16_f32 v46, v62, v63
    s_set_gpr_idx_on s40, 0xc
    ds_read2_b32 v[50:51], v2 offset0:144 offset1:160
    v_mfma_f32_4x4x4_16b_bf16 v[156:159], v[8:9], v[32:33], v[156:159] cbsz:4 abid:0
    s_set_gpr_idx_on s41, 0xc
    s_lshr_b64 s[40:41], s[40:41], 8
    v_mfma_f32_4x4x4_16b_bf16 v[156:159], v[8:9], v[32:33], v[156:159] cbsz:4 abid:1
    s_set_gpr_idx_on s40, 0xc
    ds_read_b128 v[56:59], v0 offset:0
    v_mfma_f32_4x4x4_16b_bf16 v[156:159], v[8:9], v[34:35], v[156:159] cbsz:4 abid:2
    s_set_gpr_idx_on s41, 0xc
    s_lshr_b64 s[40:41], s[40:41], 8
    v_mfma_f32_4x4x4_16b_bf16 v[156:159], v[8:9], v[34:35], v[156:159] cbsz:4 abid:3
    s_set_gpr_idx_on s40, 0xc
    ds_read_b128 v[60:63], v0 offset:1024
    v_mfma_f32_4x4x4_16b_bf16 v[156:159], v[8:9], v[36:37], v[156:159] cbsz:4 abid:4
    s_set_gpr_idx_on s41, 0xc
    s_lshr_b64 s[40:41], s[40:41], 8
    v_mfma_f32_4x4x4_16b_bf16 v[156:159], v[8:9], v[36:37], v[156:159] cbsz:4 abid:5
    s_set_gpr_idx_on s40, 0xc
    ds_read_b128 v[16:19], v5 offset:1024
    v_mfma_f32_4x4x4_16b_bf16 v[156:159], v[8:9], v[38:39], v[156:159] cbsz:4 abid:6
    s_set_gpr_idx_on s41, 0xc
    ds_read_b128 v[20:23], v7 offset:1024
    v_mfma_f32_4x4x4_16b_bf16 v[156:159], v[8:9], v[38:39], v[156:159] cbsz:4 abid:7
    s_set_gpr_idx_on s42, 0xc
    ds_read_b64_tr_b16 v[10:11], v1 offset:0
    v_mfma_f32_4x4x4_16b_bf16 v[156:159], v[8:9], v[40:41], v[156:159] cbsz:4 abid:8
    s_set_gpr_idx_on s43, 0xc
    s_lshr_b64 s[42:43], s[42:43], 8
    v_mfma_f32_4x4x4_16b_bf16 v[156:159], v[8:9], v[40:41], v[156:159] cbsz:4 abid:9
    s_set_gpr_idx_on s42, 0xc
    ds_read_b64_tr_b16 v[12:13], v1 offset:256
    v_mfma_f32_4x4x4_16b_bf16 v[156:159], v[8:9], v[42:43], v[156:159] cbsz:4 abid:10
    s_set_gpr_idx_on s43, 0xc
    s_lshr_b64 s[42:43], s[42:43], 8
    v_mfma_f32_4x4x4_16b_bf16 v[156:159], v[8:9], v[42:43], v[156:159] cbsz:4 abid:11
    s_set_gpr_idx_on s42, 0xc
    ds_read_b64_tr_b16 v[64:65], v1 offset:512
    v_mfma_f32_4x4x4_16b_bf16 v[156:159], v[8:9], v[44:45], v[156:159] cbsz:4 abid:12
    s_set_gpr_idx_on s43, 0xc
    s_lshr_b64 s[42:43], s[42:43], 8
    v_mfma_f32_4x4x4_16b_bf16 v[156:159], v[8:9], v[44:45], v[156:159] cbsz:4 abid:13
    s_set_gpr_idx_on s42, 0xc
    ds_read_b64_tr_b16 v[66:67], v1 offset:768
    v_mfma_f32_4x4x4_16b_bf16 v[156:159], v[8:9], v[46:47], v[156:159] cbsz:4 abid:14
    s_set_gpr_idx_on s43, 0xc
    ds_read_b64 v[48:49], v3 offset:11008
    v_mfma_f32_4x4x4_16b_bf16 v[156:159], v[8:9], v[46:47], v[156:159] cbsz:4 abid:15
    s_set_gpr_idx_off
    s_sub_u32 s39, s39, 1
    s_cbranch_scc1 tp_main_kernel_a_done
    s_setprio 3
    s_waitcnt lgkmcnt(1)
    v_mfma_f32_32x32x16_bf16 v[32:47], v[16:19], v[56:59], 0
    v_mad_u32_u16 v50, v50, s78, v14 op_sel:[1,0,0,0]
    s_add_u32 m0, s33, 5120
    v_mad_u32_u16 v51, v51, s78, v14 op_sel:[1,0,0,0]
    buffer_load_dwordx4 v50, s[4:7], s80 offen lds
    s_cmp_ge_i32 s39, 3
    s_cselect_b32 s80, s68, s69
    s_add_u32 m0, s33, 0
    v_mfma_f32_32x32x16_bf16 v[32:47], v[20:23], v[60:63], v[32:47]
    buffer_load_dwordx4 v51, s[4:7], s80 offen lds
    v_add_u32 v2, 512, v2
    v_add_u32 v3, 512, v3
    v_add_u32 v4, 256, v4
    s_nop 0
    s_waitcnt vmcnt(5) lgkmcnt(0)
    v_perm_b32 v8, v49, v48, v6
    v_mfma_f32_32x32x16_bf16 v[48:63], v[16:19], v[24:27], 0
    s_lshl_b64 s[40:41], s[44:45], 2
    s_lshl_b64 s[42:43], s[46:47], 2
    ds_read_b64_tr_b16 v[16:17], v1 offset:1024
    ds_read_b64_tr_b16 v[18:19], v1 offset:1280
    v_mul_f32 v32, v32, v10
    v_mul_f32 v33, v33, v11
    v_mul_f32 v34, v34, v12
    v_mul_f32 v35, v35, v13
    v_mfma_f32_32x32x16_bf16 v[48:63], v[20:23], v[28:31], v[48:63]
    ds_read_b64_tr_b16 v[20:21], v1 offset:1536
    ds_read_b64_tr_b16 v[22:23], v1 offset:1792
    v_mul_f32 v36, v36, v64
    v_mul_f32 v37, v37, v65
    v_mul_f32 v38, v38, v66
    v_mul_f32 v39, v39, v67
    v_cvt_pk_bf16_f32 v33, v32, v33
    v_cvt_pk_bf16_f32 v35, v34, v35
    v_cvt_pk_bf16_f32 v37, v36, v37
    v_cvt_pk_bf16_f32 v39, v38, v39
    s_waitcnt lgkmcnt(2)
    v_mul_f32 v40, v40, v16
    v_mul_f32 v41, v41, v17
    v_mul_f32 v42, v42, v18
    v_mul_f32 v43, v43, v19
    v_mul_f32 v48, v48, v10
    v_mul_f32 v49, v49, v11
    v_mul_f32 v50, v50, v12
    v_mul_f32 v51, v51, v13
    v_mul_f32 v52, v52, v64
    v_mul_f32 v53, v53, v65
    v_mul_f32 v54, v54, v66
    v_mul_f32 v55, v55, v67
    s_waitcnt lgkmcnt(0)
    s_buffer_load_dwordx4 s[44:47], s[88:91], s92
    s_add_u32 s92, s92, 16
    v_cvt_pk_bf16_f32 v32, v48, v49
    v_cvt_pk_bf16_f32 v34, v50, v51
    v_cvt_pk_bf16_f32 v36, v52, v53
    v_cvt_pk_bf16_f32 v38, v54, v55
    v_mul_f32 v44, v44, v20
    v_mul_f32 v45, v45, v21
    v_mul_f32 v46, v46, v22
    v_mul_f32 v47, v47, v23
    v_mul_f32 v56, v56, v16
    v_mul_f32 v57, v57, v17
    v_mul_f32 v58, v58, v18
    v_mul_f32 v59, v59, v19
    v_cvt_pk_bf16_f32 v41, v40, v41
    v_cvt_pk_bf16_f32 v43, v42, v43
    v_cvt_pk_bf16_f32 v45, v44, v45
    v_cvt_pk_bf16_f32 v47, v46, v47
    v_mul_f32 v60, v60, v20
    v_mul_f32 v61, v61, v21
    v_mul_f32 v62, v62, v22
    v_mul_f32 v63, v63, v23
    v_cvt_pk_bf16_f32 v40, v56, v57
    v_cvt_pk_bf16_f32 v42, v58, v59
    v_cvt_pk_bf16_f32 v44, v60, v61
    v_cvt_pk_bf16_f32 v46, v62, v63
    s_set_gpr_idx_on s40, 0xc
    ds_read_b32 v53, v4 offset:40640
    v_mfma_f32_4x4x4_16b_bf16 v[156:159], v[8:9], v[32:33], v[156:159] cbsz:4 abid:0
    s_set_gpr_idx_on s41, 0xc
    s_lshr_b64 s[40:41], s[40:41], 8
    ds_read2_b32 v[50:51], v2 offset0:48 offset1:64
    v_mfma_f32_4x4x4_16b_bf16 v[156:159], v[8:9], v[32:33], v[156:159] cbsz:4 abid:1
    s_set_gpr_idx_on s40, 0xc
    ds_read_b128 v[56:59], v0 offset:0
    v_mfma_f32_4x4x4_16b_bf16 v[156:159], v[8:9], v[34:35], v[156:159] cbsz:4 abid:2
    s_set_gpr_idx_on s41, 0xc
    s_lshr_b64 s[40:41], s[40:41], 8
    v_mfma_f32_4x4x4_16b_bf16 v[156:159], v[8:9], v[34:35], v[156:159] cbsz:4 abid:3
    s_set_gpr_idx_on s40, 0xc
    ds_read_b128 v[60:63], v0 offset:1024
    v_mfma_f32_4x4x4_16b_bf16 v[156:159], v[8:9], v[36:37], v[156:159] cbsz:4 abid:4
    s_set_gpr_idx_on s41, 0xc
    s_lshr_b64 s[40:41], s[40:41], 8
    v_mfma_f32_4x4x4_16b_bf16 v[156:159], v[8:9], v[36:37], v[156:159] cbsz:4 abid:5
    s_set_gpr_idx_on s40, 0xc
    ds_read_b128 v[16:19], v5 offset:1536
    v_mfma_f32_4x4x4_16b_bf16 v[156:159], v[8:9], v[38:39], v[156:159] cbsz:4 abid:6
    s_set_gpr_idx_on s41, 0xc
    ds_read_b128 v[20:23], v7 offset:1536
    v_mfma_f32_4x4x4_16b_bf16 v[156:159], v[8:9], v[38:39], v[156:159] cbsz:4 abid:7
    s_set_gpr_idx_on s42, 0xc
    ds_read_b64_tr_b16 v[10:11], v1 offset:2048
    v_mfma_f32_4x4x4_16b_bf16 v[156:159], v[8:9], v[40:41], v[156:159] cbsz:4 abid:8
    s_set_gpr_idx_on s43, 0xc
    s_lshr_b64 s[42:43], s[42:43], 8
    v_mfma_f32_4x4x4_16b_bf16 v[156:159], v[8:9], v[40:41], v[156:159] cbsz:4 abid:9
    s_set_gpr_idx_on s42, 0xc
    ds_read_b64_tr_b16 v[12:13], v1 offset:2304
    v_mfma_f32_4x4x4_16b_bf16 v[156:159], v[8:9], v[42:43], v[156:159] cbsz:4 abid:10
    s_set_gpr_idx_on s43, 0xc
    s_lshr_b64 s[42:43], s[42:43], 8
    v_mfma_f32_4x4x4_16b_bf16 v[156:159], v[8:9], v[42:43], v[156:159] cbsz:4 abid:11
    s_set_gpr_idx_on s42, 0xc
    ds_read_b64_tr_b16 v[64:65], v1 offset:2560
    v_mfma_f32_4x4x4_16b_bf16 v[156:159], v[8:9], v[44:45], v[156:159] cbsz:4 abid:12
    s_set_gpr_idx_on s43, 0xc
    s_lshr_b64 s[42:43], s[42:43], 8
    v_mfma_f32_4x4x4_16b_bf16 v[156:159], v[8:9], v[44:45], v[156:159] cbsz:4 abid:13
    s_set_gpr_idx_on s42, 0xc
    ds_read_b64_tr_b16 v[66:67], v1 offset:2816
    v_mfma_f32_4x4x4_16b_bf16 v[156:159], v[8:9], v[46:47], v[156:159] cbsz:4 abid:14
    s_set_gpr_idx_on s43, 0xc
    ds_read_b64 v[48:49], v3 offset:10624
    v_mfma_f32_4x4x4_16b_bf16 v[156:159], v[8:9], v[46:47], v[156:159] cbsz:4 abid:15
    s_set_gpr_idx_off
    s_sub_u32 s39, s39, 1
    s_cbranch_scc1 tp_main_kernel_a_done
    s_waitcnt lgkmcnt(1)
    v_mfma_f32_32x32x16_bf16 v[32:47], v[16:19], v[56:59], 0
    v_mad_u32_u16 v50, v50, s78, v14 op_sel:[1,0,0,0]
    s_add_u32 m0, s33, 1024
    v_mad_u32_u16 v51, v51, s78, v14 op_sel:[1,0,0,0]
    buffer_load_dwordx4 v50, s[4:7], s80 offen lds
    s_cmp_ge_i32 s39, 3
    s_cselect_b32 s80, s68, s69
    s_add_u32 m0, s33, 2048
    v_mfma_f32_32x32x16_bf16 v[32:47], v[20:23], v[60:63], v[32:47]
    buffer_load_dwordx4 v51, s[4:7], s80 offen lds
    s_add_u32 m0, s33, 7168
    v_bfi_b32 v53, 31, v0, v53
    buffer_load_dwordx4 v53, s[8:11], s80 offen lds
    s_nop 0
    s_waitcnt vmcnt(5) lgkmcnt(0)
    v_perm_b32 v8, v49, v48, v6
    v_mfma_f32_32x32x16_bf16 v[48:63], v[16:19], v[24:27], 0
    s_lshl_b64 s[40:41], s[44:45], 2
    s_lshl_b64 s[42:43], s[46:47], 2
    ds_read_b64_tr_b16 v[16:17], v1 offset:3072
    ds_read_b64_tr_b16 v[18:19], v1 offset:3328
    v_mul_f32 v32, v32, v10
    v_mul_f32 v33, v33, v11
    v_mul_f32 v34, v34, v12
    v_mul_f32 v35, v35, v13
    v_mfma_f32_32x32x16_bf16 v[48:63], v[20:23], v[28:31], v[48:63]
    ds_read_b64_tr_b16 v[20:21], v1 offset:3584
    ds_read_b64_tr_b16 v[22:23], v1 offset:3840
    v_mul_f32 v36, v36, v64
    v_mul_f32 v37, v37, v65
    v_mul_f32 v38, v38, v66
    v_mul_f32 v39, v39, v67
    v_cvt_pk_bf16_f32 v33, v32, v33
    v_cvt_pk_bf16_f32 v35, v34, v35
    v_cvt_pk_bf16_f32 v37, v36, v37
    v_cvt_pk_bf16_f32 v39, v38, v39
    s_waitcnt lgkmcnt(2)
    v_mul_f32 v40, v40, v16
    v_mul_f32 v41, v41, v17
    v_mul_f32 v42, v42, v18
    v_mul_f32 v43, v43, v19
    v_mul_f32 v48, v48, v10
    v_mul_f32 v49, v49, v11
    v_mul_f32 v50, v50, v12
    v_mul_f32 v51, v51, v13
    v_mul_f32 v52, v52, v64
    v_mul_f32 v53, v53, v65
    v_mul_f32 v54, v54, v66
    v_mul_f32 v55, v55, v67
    s_waitcnt lgkmcnt(0)
    s_buffer_load_dwordx4 s[44:47], s[88:91], s92
    s_add_u32 s92, s92, 16
    v_cvt_pk_bf16_f32 v32, v48, v49
    v_cvt_pk_bf16_f32 v34, v50, v51
    v_cvt_pk_bf16_f32 v36, v52, v53
    v_cvt_pk_bf16_f32 v38, v54, v55
    v_mul_f32 v44, v44, v20
    v_mul_f32 v45, v45, v21
    v_mul_f32 v46, v46, v22
    v_mul_f32 v47, v47, v23
    v_mul_f32 v56, v56, v16
    v_mul_f32 v57, v57, v17
    v_mul_f32 v58, v58, v18
    v_mul_f32 v59, v59, v19
    v_cvt_pk_bf16_f32 v41, v40, v41
    v_cvt_pk_bf16_f32 v43, v42, v43
    v_cvt_pk_bf16_f32 v45, v44, v45
    v_cvt_pk_bf16_f32 v47, v46, v47
    v_mul_f32 v60, v60, v20
    v_mul_f32 v61, v61, v21
    v_mul_f32 v62, v62, v22
    v_mul_f32 v63, v63, v23
    v_cvt_pk_bf16_f32 v40, v56, v57
    v_cvt_pk_bf16_f32 v42, v58, v59
    v_cvt_pk_bf16_f32 v44, v60, v61
    v_cvt_pk_bf16_f32 v46, v62, v63
    s_set_gpr_idx_on s40, 0xc
    ds_read2_b32 v[50:51], v2 offset0:80 offset1:96
    v_mfma_f32_4x4x4_16b_bf16 v[156:159], v[8:9], v[32:33], v[156:159] cbsz:4 abid:0
    s_set_gpr_idx_on s41, 0xc
    s_lshr_b64 s[40:41], s[40:41], 8
    v_mfma_f32_4x4x4_16b_bf16 v[156:159], v[8:9], v[32:33], v[156:159] cbsz:4 abid:1
    s_set_gpr_idx_on s40, 0xc
    ds_read_b128 v[56:59], v0 offset:0
    v_mfma_f32_4x4x4_16b_bf16 v[156:159], v[8:9], v[34:35], v[156:159] cbsz:4 abid:2
    s_set_gpr_idx_on s41, 0xc
    s_lshr_b64 s[40:41], s[40:41], 8
    v_mfma_f32_4x4x4_16b_bf16 v[156:159], v[8:9], v[34:35], v[156:159] cbsz:4 abid:3
    s_set_gpr_idx_on s40, 0xc
    ds_read_b128 v[60:63], v0 offset:1024
    v_mfma_f32_4x4x4_16b_bf16 v[156:159], v[8:9], v[36:37], v[156:159] cbsz:4 abid:4
    s_set_gpr_idx_on s41, 0xc
    s_lshr_b64 s[40:41], s[40:41], 8
    v_mfma_f32_4x4x4_16b_bf16 v[156:159], v[8:9], v[36:37], v[156:159] cbsz:4 abid:5
    s_set_gpr_idx_on s40, 0xc
    ds_read_b128 v[16:19], v5 offset:0
    v_mfma_f32_4x4x4_16b_bf16 v[156:159], v[8:9], v[38:39], v[156:159] cbsz:4 abid:6
    s_set_gpr_idx_on s41, 0xc
    ds_read_b128 v[20:23], v7 offset:0
    v_mfma_f32_4x4x4_16b_bf16 v[156:159], v[8:9], v[38:39], v[156:159] cbsz:4 abid:7
    s_set_gpr_idx_on s42, 0xc
    ds_read_b64_tr_b16 v[10:11], v1 offset:4096
    v_mfma_f32_4x4x4_16b_bf16 v[156:159], v[8:9], v[40:41], v[156:159] cbsz:4 abid:8
    s_set_gpr_idx_on s43, 0xc
    s_lshr_b64 s[42:43], s[42:43], 8
    v_mfma_f32_4x4x4_16b_bf16 v[156:159], v[8:9], v[40:41], v[156:159] cbsz:4 abid:9
    s_set_gpr_idx_on s42, 0xc
    ds_read_b64_tr_b16 v[12:13], v1 offset:4352
    v_mfma_f32_4x4x4_16b_bf16 v[156:159], v[8:9], v[42:43], v[156:159] cbsz:4 abid:10
    s_set_gpr_idx_on s43, 0xc
    s_lshr_b64 s[42:43], s[42:43], 8
    v_mfma_f32_4x4x4_16b_bf16 v[156:159], v[8:9], v[42:43], v[156:159] cbsz:4 abid:11
    s_set_gpr_idx_on s42, 0xc
    ds_read_b64_tr_b16 v[64:65], v1 offset:4608
    v_mfma_f32_4x4x4_16b_bf16 v[156:159], v[8:9], v[44:45], v[156:159] cbsz:4 abid:12
    s_set_gpr_idx_on s43, 0xc
    s_lshr_b64 s[42:43], s[42:43], 8
    v_mfma_f32_4x4x4_16b_bf16 v[156:159], v[8:9], v[44:45], v[156:159] cbsz:4 abid:13
    s_set_gpr_idx_on s42, 0xc
    ds_read_b64_tr_b16 v[66:67], v1 offset:4864
    v_mfma_f32_4x4x4_16b_bf16 v[156:159], v[8:9], v[46:47], v[156:159] cbsz:4 abid:14
    s_set_gpr_idx_on s43, 0xc
    ds_read_b64 v[48:49], v3 offset:10752
    v_mfma_f32_4x4x4_16b_bf16 v[156:159], v[8:9], v[46:47], v[156:159] cbsz:4 abid:15
    s_set_gpr_idx_off
    s_sub_u32 s39, s39, 1
    s_cbranch_scc1 tp_main_kernel_a_done
    s_setprio 2
    s_cmp_lt_u32 s3, 4
    s_cbranch_scc1 1
    s_setprio 3
    s_waitcnt lgkmcnt(1)
    v_mfma_f32_32x32x16_bf16 v[32:47], v[16:19], v[56:59], 0
    v_mad_u32_u16 v50, v50, s78, v14 op_sel:[1,0,0,0]
    s_add_u32 m0, s33, 3072
    v_mad_u32_u16 v51, v51, s78, v14 op_sel:[1,0,0,0]
    buffer_load_dwordx4 v50, s[4:7], s80 offen lds
    s_cmp_ge_i32 s39, 3
    s_cselect_b32 s80, s68, s69
    s_add_u32 m0, s33, 4096
    v_mfma_f32_32x32x16_bf16 v[32:47], v[20:23], v[60:63], v[32:47]
    buffer_load_dwordx4 v51, s[4:7], s80 offen lds
    s_nop 3
    s_waitcnt vmcnt(5) lgkmcnt(0)
    v_perm_b32 v8, v49, v48, v6
    v_mfma_f32_32x32x16_bf16 v[48:63], v[16:19], v[24:27], 0
    s_lshl_b64 s[40:41], s[44:45], 2
    s_lshl_b64 s[42:43], s[46:47], 2
    ds_read_b64_tr_b16 v[16:17], v1 offset:5120
    ds_read_b64_tr_b16 v[18:19], v1 offset:5376
    v_mul_f32 v32, v32, v10
    v_mul_f32 v33, v33, v11
    v_mul_f32 v34, v34, v12
    v_mul_f32 v35, v35, v13
    v_mfma_f32_32x32x16_bf16 v[48:63], v[20:23], v[28:31], v[48:63]
    ds_read_b64_tr_b16 v[20:21], v1 offset:5632
    ds_read_b64_tr_b16 v[22:23], v1 offset:5888
    v_mul_f32 v36, v36, v64
    v_mul_f32 v37, v37, v65
    v_mul_f32 v38, v38, v66
    v_mul_f32 v39, v39, v67
    v_cvt_pk_bf16_f32 v33, v32, v33
    v_cvt_pk_bf16_f32 v35, v34, v35
    v_cvt_pk_bf16_f32 v37, v36, v37
    v_cvt_pk_bf16_f32 v39, v38, v39
    s_waitcnt lgkmcnt(2)
    v_mul_f32 v40, v40, v16
    v_mul_f32 v41, v41, v17
    v_mul_f32 v42, v42, v18
    v_mul_f32 v43, v43, v19
    v_mul_f32 v48, v48, v10
    v_mul_f32 v49, v49, v11
    v_mul_f32 v50, v50, v12
    v_mul_f32 v51, v51, v13
    v_mul_f32 v52, v52, v64
    v_mul_f32 v53, v53, v65
    v_mul_f32 v54, v54, v66
    v_mul_f32 v55, v55, v67
    s_waitcnt lgkmcnt(0)
    s_buffer_load_dwordx4 s[44:47], s[88:91], s92
    s_add_u32 s92, s92, 16
    v_cvt_pk_bf16_f32 v32, v48, v49
    v_cvt_pk_bf16_f32 v34, v50, v51
    v_cvt_pk_bf16_f32 v36, v52, v53
    v_cvt_pk_bf16_f32 v38, v54, v55
    v_mul_f32 v44, v44, v20
    v_mul_f32 v45, v45, v21
    v_mul_f32 v46, v46, v22
    v_mul_f32 v47, v47, v23
    v_mul_f32 v56, v56, v16
    v_mul_f32 v57, v57, v17
    v_mul_f32 v58, v58, v18
    v_mul_f32 v59, v59, v19
    v_cvt_pk_bf16_f32 v41, v40, v41
    v_cvt_pk_bf16_f32 v43, v42, v43
    v_cvt_pk_bf16_f32 v45, v44, v45
    v_cvt_pk_bf16_f32 v47, v46, v47
    v_mul_f32 v60, v60, v20
    v_mul_f32 v61, v61, v21
    v_mul_f32 v62, v62, v22
    v_mul_f32 v63, v63, v23
    v_cvt_pk_bf16_f32 v40, v56, v57
    v_cvt_pk_bf16_f32 v42, v58, v59
    v_cvt_pk_bf16_f32 v44, v60, v61
    v_cvt_pk_bf16_f32 v46, v62, v63
    s_set_gpr_idx_on s40, 0xc
    ds_read_b32 v53, v4 offset:40768
    v_mfma_f32_4x4x4_16b_bf16 v[156:159], v[8:9], v[32:33], v[156:159] cbsz:4 abid:0
    s_set_gpr_idx_on s41, 0xc
    s_lshr_b64 s[40:41], s[40:41], 8
    ds_read2_b32 v[50:51], v2 offset0:112 offset1:128
    v_mfma_f32_4x4x4_16b_bf16 v[156:159], v[8:9], v[32:33], v[156:159] cbsz:4 abid:1
    s_set_gpr_idx_on s40, 0xc
    ds_read_b128 v[56:59], v0 offset:0
    v_mfma_f32_4x4x4_16b_bf16 v[156:159], v[8:9], v[34:35], v[156:159] cbsz:4 abid:2
    s_set_gpr_idx_on s41, 0xc
    s_lshr_b64 s[40:41], s[40:41], 8
    v_mfma_f32_4x4x4_16b_bf16 v[156:159], v[8:9], v[34:35], v[156:159] cbsz:4 abid:3
    s_set_gpr_idx_on s40, 0xc
    ds_read_b128 v[60:63], v0 offset:1024
    v_mfma_f32_4x4x4_16b_bf16 v[156:159], v[8:9], v[36:37], v[156:159] cbsz:4 abid:4
    s_set_gpr_idx_on s41, 0xc
    s_lshr_b64 s[40:41], s[40:41], 8
    v_mfma_f32_4x4x4_16b_bf16 v[156:159], v[8:9], v[36:37], v[156:159] cbsz:4 abid:5
    s_set_gpr_idx_on s40, 0xc
    ds_read_b128 v[16:19], v5 offset:512
    v_mfma_f32_4x4x4_16b_bf16 v[156:159], v[8:9], v[38:39], v[156:159] cbsz:4 abid:6
    s_set_gpr_idx_on s41, 0xc
    ds_read_b128 v[20:23], v7 offset:512
    v_mfma_f32_4x4x4_16b_bf16 v[156:159], v[8:9], v[38:39], v[156:159] cbsz:4 abid:7
    s_set_gpr_idx_on s42, 0xc
    ds_read_b64_tr_b16 v[10:11], v1 offset:0
    v_mfma_f32_4x4x4_16b_bf16 v[156:159], v[8:9], v[40:41], v[156:159] cbsz:4 abid:8
    s_set_gpr_idx_on s43, 0xc
    s_lshr_b64 s[42:43], s[42:43], 8
    v_mfma_f32_4x4x4_16b_bf16 v[156:159], v[8:9], v[40:41], v[156:159] cbsz:4 abid:9
    s_set_gpr_idx_on s42, 0xc
    ds_read_b64_tr_b16 v[12:13], v1 offset:256
    v_mfma_f32_4x4x4_16b_bf16 v[156:159], v[8:9], v[42:43], v[156:159] cbsz:4 abid:10
    s_set_gpr_idx_on s43, 0xc
    s_lshr_b64 s[42:43], s[42:43], 8
    v_mfma_f32_4x4x4_16b_bf16 v[156:159], v[8:9], v[42:43], v[156:159] cbsz:4 abid:11
    s_set_gpr_idx_on s42, 0xc
    ds_read_b64_tr_b16 v[64:65], v1 offset:512
    v_mfma_f32_4x4x4_16b_bf16 v[156:159], v[8:9], v[44:45], v[156:159] cbsz:4 abid:12
    s_set_gpr_idx_on s43, 0xc
    s_lshr_b64 s[42:43], s[42:43], 8
    v_mfma_f32_4x4x4_16b_bf16 v[156:159], v[8:9], v[44:45], v[156:159] cbsz:4 abid:13
    s_set_gpr_idx_on s42, 0xc
    ds_read_b64_tr_b16 v[66:67], v1 offset:768
    v_mfma_f32_4x4x4_16b_bf16 v[156:159], v[8:9], v[46:47], v[156:159] cbsz:4 abid:14
    s_set_gpr_idx_on s43, 0xc
    ds_read_b64 v[48:49], v3 offset:10880
    v_mfma_f32_4x4x4_16b_bf16 v[156:159], v[8:9], v[46:47], v[156:159] cbsz:4 abid:15
    s_set_gpr_idx_off
    s_sub_u32 s39, s39, 1
    s_cbranch_scc1 tp_main_kernel_a_done
    s_setprio 3
    s_waitcnt lgkmcnt(1)
    v_mfma_f32_32x32x16_bf16 v[32:47], v[16:19], v[56:59], 0
    v_mad_u32_u16 v50, v50, s78, v14 op_sel:[1,0,0,0]
    s_add_u32 m0, s33, 5120
    v_mad_u32_u16 v51, v51, s78, v14 op_sel:[1,0,0,0]
    buffer_load_dwordx4 v50, s[4:7], s80 offen lds
    s_cmp_ge_i32 s39, 3
    s_cselect_b32 s80, s68, s69
    s_add_u32 m0, s33, 0
    v_mfma_f32_32x32x16_bf16 v[32:47], v[20:23], v[60:63], v[32:47]
    buffer_load_dwordx4 v51, s[4:7], s80 offen lds
    s_add_u32 m0, s33, 6144
    v_bfi_b32 v53, 31, v0, v53
    buffer_load_dwordx4 v53, s[8:11], s80 offen lds
    s_nop 0
    s_waitcnt vmcnt(5) lgkmcnt(0)
    v_perm_b32 v8, v49, v48, v6
    v_mfma_f32_32x32x16_bf16 v[48:63], v[16:19], v[24:27], 0
    s_lshl_b64 s[40:41], s[44:45], 2
    s_lshl_b64 s[42:43], s[46:47], 2
    ds_read_b64_tr_b16 v[16:17], v1 offset:1024
    ds_read_b64_tr_b16 v[18:19], v1 offset:1280
    v_mul_f32 v32, v32, v10
    v_mul_f32 v33, v33, v11
    v_mul_f32 v34, v34, v12
    v_mul_f32 v35, v35, v13
    v_mfma_f32_32x32x16_bf16 v[48:63], v[20:23], v[28:31], v[48:63]
    ds_read_b64_tr_b16 v[20:21], v1 offset:1536
    ds_read_b64_tr_b16 v[22:23], v1 offset:1792
    v_mul_f32 v36, v36, v64
    v_mul_f32 v37, v37, v65
    v_mul_f32 v38, v38, v66
    v_mul_f32 v39, v39, v67
    v_cvt_pk_bf16_f32 v33, v32, v33
    v_cvt_pk_bf16_f32 v35, v34, v35
    v_cvt_pk_bf16_f32 v37, v36, v37
    v_cvt_pk_bf16_f32 v39, v38, v39
    s_waitcnt lgkmcnt(2)
    v_mul_f32 v40, v40, v16
    v_mul_f32 v41, v41, v17
    v_mul_f32 v42, v42, v18
    v_mul_f32 v43, v43, v19
    v_mul_f32 v48, v48, v10
    v_mul_f32 v49, v49, v11
    v_mul_f32 v50, v50, v12
    v_mul_f32 v51, v51, v13
    v_mul_f32 v52, v52, v64
    v_mul_f32 v53, v53, v65
    v_mul_f32 v54, v54, v66
    v_mul_f32 v55, v55, v67
    s_waitcnt lgkmcnt(0)
    s_buffer_load_dwordx4 s[44:47], s[88:91], s92
    s_add_u32 s92, s92, 16
    v_cvt_pk_bf16_f32 v32, v48, v49
    v_cvt_pk_bf16_f32 v34, v50, v51
    v_cvt_pk_bf16_f32 v36, v52, v53
    v_cvt_pk_bf16_f32 v38, v54, v55
    v_mul_f32 v44, v44, v20
    v_mul_f32 v45, v45, v21
    v_mul_f32 v46, v46, v22
    v_mul_f32 v47, v47, v23
    v_mul_f32 v56, v56, v16
    v_mul_f32 v57, v57, v17
    v_mul_f32 v58, v58, v18
    v_mul_f32 v59, v59, v19
    v_cvt_pk_bf16_f32 v41, v40, v41
    v_cvt_pk_bf16_f32 v43, v42, v43
    v_cvt_pk_bf16_f32 v45, v44, v45
    v_cvt_pk_bf16_f32 v47, v46, v47
    v_mul_f32 v60, v60, v20
    v_mul_f32 v61, v61, v21
    v_mul_f32 v62, v62, v22
    v_mul_f32 v63, v63, v23
    v_cvt_pk_bf16_f32 v40, v56, v57
    v_cvt_pk_bf16_f32 v42, v58, v59
    v_cvt_pk_bf16_f32 v44, v60, v61
    v_cvt_pk_bf16_f32 v46, v62, v63
    s_set_gpr_idx_on s40, 0xc
    ds_read2_b32 v[50:51], v2 offset0:144 offset1:160
    v_mfma_f32_4x4x4_16b_bf16 v[156:159], v[8:9], v[32:33], v[156:159] cbsz:4 abid:0
    s_set_gpr_idx_on s41, 0xc
    s_lshr_b64 s[40:41], s[40:41], 8
    v_mfma_f32_4x4x4_16b_bf16 v[156:159], v[8:9], v[32:33], v[156:159] cbsz:4 abid:1
    s_set_gpr_idx_on s40, 0xc
    ds_read_b128 v[56:59], v0 offset:0
    v_mfma_f32_4x4x4_16b_bf16 v[156:159], v[8:9], v[34:35], v[156:159] cbsz:4 abid:2
    s_set_gpr_idx_on s41, 0xc
    s_lshr_b64 s[40:41], s[40:41], 8
    v_mfma_f32_4x4x4_16b_bf16 v[156:159], v[8:9], v[34:35], v[156:159] cbsz:4 abid:3
    s_set_gpr_idx_on s40, 0xc
    ds_read_b128 v[60:63], v0 offset:1024
    v_mfma_f32_4x4x4_16b_bf16 v[156:159], v[8:9], v[36:37], v[156:159] cbsz:4 abid:4
    s_set_gpr_idx_on s41, 0xc
    s_lshr_b64 s[40:41], s[40:41], 8
    v_mfma_f32_4x4x4_16b_bf16 v[156:159], v[8:9], v[36:37], v[156:159] cbsz:4 abid:5
    s_set_gpr_idx_on s40, 0xc
    ds_read_b128 v[16:19], v5 offset:1024
    v_mfma_f32_4x4x4_16b_bf16 v[156:159], v[8:9], v[38:39], v[156:159] cbsz:4 abid:6
    s_set_gpr_idx_on s41, 0xc
    ds_read_b128 v[20:23], v7 offset:1024
    v_mfma_f32_4x4x4_16b_bf16 v[156:159], v[8:9], v[38:39], v[156:159] cbsz:4 abid:7
    s_set_gpr_idx_on s42, 0xc
    ds_read_b64_tr_b16 v[10:11], v1 offset:2048
    v_mfma_f32_4x4x4_16b_bf16 v[156:159], v[8:9], v[40:41], v[156:159] cbsz:4 abid:8
    s_set_gpr_idx_on s43, 0xc
    s_lshr_b64 s[42:43], s[42:43], 8
    v_mfma_f32_4x4x4_16b_bf16 v[156:159], v[8:9], v[40:41], v[156:159] cbsz:4 abid:9
    s_set_gpr_idx_on s42, 0xc
    ds_read_b64_tr_b16 v[12:13], v1 offset:2304
    v_mfma_f32_4x4x4_16b_bf16 v[156:159], v[8:9], v[42:43], v[156:159] cbsz:4 abid:10
    s_set_gpr_idx_on s43, 0xc
    s_lshr_b64 s[42:43], s[42:43], 8
    v_mfma_f32_4x4x4_16b_bf16 v[156:159], v[8:9], v[42:43], v[156:159] cbsz:4 abid:11
    s_set_gpr_idx_on s42, 0xc
    ds_read_b64_tr_b16 v[64:65], v1 offset:2560
    v_mfma_f32_4x4x4_16b_bf16 v[156:159], v[8:9], v[44:45], v[156:159] cbsz:4 abid:12
    s_set_gpr_idx_on s43, 0xc
    s_lshr_b64 s[42:43], s[42:43], 8
    v_mfma_f32_4x4x4_16b_bf16 v[156:159], v[8:9], v[44:45], v[156:159] cbsz:4 abid:13
    s_set_gpr_idx_on s42, 0xc
    ds_read_b64_tr_b16 v[66:67], v1 offset:2816
    v_mfma_f32_4x4x4_16b_bf16 v[156:159], v[8:9], v[46:47], v[156:159] cbsz:4 abid:14
    s_set_gpr_idx_on s43, 0xc
    ds_read_b64 v[48:49], v3 offset:11008
    v_mfma_f32_4x4x4_16b_bf16 v[156:159], v[8:9], v[46:47], v[156:159] cbsz:4 abid:15
    s_set_gpr_idx_off
    s_sub_u32 s39, s39, 1
    s_cbranch_scc1 tp_main_kernel_a_done
    s_waitcnt lgkmcnt(1)
    v_mfma_f32_32x32x16_bf16 v[32:47], v[16:19], v[56:59], 0
    v_mad_u32_u16 v50, v50, s78, v14 op_sel:[1,0,0,0]
    s_add_u32 m0, s33, 1024
    v_mad_u32_u16 v51, v51, s78, v14 op_sel:[1,0,0,0]
    buffer_load_dwordx4 v50, s[4:7], s80 offen lds
    s_cmp_ge_i32 s39, 3
    s_cselect_b32 s80, s68, s69
    s_add_u32 m0, s33, 2048
    v_mfma_f32_32x32x16_bf16 v[32:47], v[20:23], v[60:63], v[32:47]
    buffer_load_dwordx4 v51, s[4:7], s80 offen lds
    v_add_u32 v2, 512, v2
    v_add_u32 v3, 512, v3
    v_add_u32 v4, 256, v4
    s_nop 0
    s_waitcnt vmcnt(5) lgkmcnt(0)
    v_perm_b32 v8, v49, v48, v6
    v_mfma_f32_32x32x16_bf16 v[48:63], v[16:19], v[24:27], 0
    s_lshl_b64 s[40:41], s[44:45], 2
    s_lshl_b64 s[42:43], s[46:47], 2
    ds_read_b64_tr_b16 v[16:17], v1 offset:3072
    ds_read_b64_tr_b16 v[18:19], v1 offset:3328
    v_mul_f32 v32, v32, v10
    v_mul_f32 v33, v33, v11
    v_mul_f32 v34, v34, v12
    v_mul_f32 v35, v35, v13
    v_mfma_f32_32x32x16_bf16 v[48:63], v[20:23], v[28:31], v[48:63]
    ds_read_b64_tr_b16 v[20:21], v1 offset:3584
    ds_read_b64_tr_b16 v[22:23], v1 offset:3840
    v_mul_f32 v36, v36, v64
    v_mul_f32 v37, v37, v65
    v_mul_f32 v38, v38, v66
    v_mul_f32 v39, v39, v67
    v_cvt_pk_bf16_f32 v33, v32, v33
    v_cvt_pk_bf16_f32 v35, v34, v35
    v_cvt_pk_bf16_f32 v37, v36, v37
    v_cvt_pk_bf16_f32 v39, v38, v39
    s_waitcnt lgkmcnt(2)
    v_mul_f32 v40, v40, v16
    v_mul_f32 v41, v41, v17
    v_mul_f32 v42, v42, v18
    v_mul_f32 v43, v43, v19
    v_mul_f32 v48, v48, v10
    v_mul_f32 v49, v49, v11
    v_mul_f32 v50, v50, v12
    v_mul_f32 v51, v51, v13
    v_mul_f32 v52, v52, v64
    v_mul_f32 v53, v53, v65
    v_mul_f32 v54, v54, v66
    v_mul_f32 v55, v55, v67
    s_waitcnt lgkmcnt(0)
    s_buffer_load_dwordx4 s[44:47], s[88:91], s92
    s_add_u32 s92, s92, 16
    v_cvt_pk_bf16_f32 v32, v48, v49
    v_cvt_pk_bf16_f32 v34, v50, v51
    v_cvt_pk_bf16_f32 v36, v52, v53
    v_cvt_pk_bf16_f32 v38, v54, v55
    v_mul_f32 v44, v44, v20
    v_mul_f32 v45, v45, v21
    v_mul_f32 v46, v46, v22
    v_mul_f32 v47, v47, v23
    v_mul_f32 v56, v56, v16
    v_mul_f32 v57, v57, v17
    v_mul_f32 v58, v58, v18
    v_mul_f32 v59, v59, v19
    v_cvt_pk_bf16_f32 v41, v40, v41
    v_cvt_pk_bf16_f32 v43, v42, v43
    v_cvt_pk_bf16_f32 v45, v44, v45
    v_cvt_pk_bf16_f32 v47, v46, v47
    v_mul_f32 v60, v60, v20
    v_mul_f32 v61, v61, v21
    v_mul_f32 v62, v62, v22
    v_mul_f32 v63, v63, v23
    v_cvt_pk_bf16_f32 v40, v56, v57
    v_cvt_pk_bf16_f32 v42, v58, v59
    v_cvt_pk_bf16_f32 v44, v60, v61
    v_cvt_pk_bf16_f32 v46, v62, v63
    s_set_gpr_idx_on s40, 0xc
    ds_read_b32 v53, v4 offset:40640
    v_mfma_f32_4x4x4_16b_bf16 v[156:159], v[8:9], v[32:33], v[156:159] cbsz:4 abid:0
    s_set_gpr_idx_on s41, 0xc
    s_lshr_b64 s[40:41], s[40:41], 8
    ds_read2_b32 v[50:51], v2 offset0:48 offset1:64
    v_mfma_f32_4x4x4_16b_bf16 v[156:159], v[8:9], v[32:33], v[156:159] cbsz:4 abid:1
    s_set_gpr_idx_on s40, 0xc
    ds_read_b128 v[56:59], v0 offset:0
    v_mfma_f32_4x4x4_16b_bf16 v[156:159], v[8:9], v[34:35], v[156:159] cbsz:4 abid:2
    s_set_gpr_idx_on s41, 0xc
    s_lshr_b64 s[40:41], s[40:41], 8
    v_mfma_f32_4x4x4_16b_bf16 v[156:159], v[8:9], v[34:35], v[156:159] cbsz:4 abid:3
    s_set_gpr_idx_on s40, 0xc
    ds_read_b128 v[60:63], v0 offset:1024
    v_mfma_f32_4x4x4_16b_bf16 v[156:159], v[8:9], v[36:37], v[156:159] cbsz:4 abid:4
    s_set_gpr_idx_on s41, 0xc
    s_lshr_b64 s[40:41], s[40:41], 8
    v_mfma_f32_4x4x4_16b_bf16 v[156:159], v[8:9], v[36:37], v[156:159] cbsz:4 abid:5
    s_set_gpr_idx_on s40, 0xc
    ds_read_b128 v[16:19], v5 offset:1536
    v_mfma_f32_4x4x4_16b_bf16 v[156:159], v[8:9], v[38:39], v[156:159] cbsz:4 abid:6
    s_set_gpr_idx_on s41, 0xc
    ds_read_b128 v[20:23], v7 offset:1536
    v_mfma_f32_4x4x4_16b_bf16 v[156:159], v[8:9], v[38:39], v[156:159] cbsz:4 abid:7
    s_set_gpr_idx_on s42, 0xc
    ds_read_b64_tr_b16 v[10:11], v1 offset:4096
    v_mfma_f32_4x4x4_16b_bf16 v[156:159], v[8:9], v[40:41], v[156:159] cbsz:4 abid:8
    s_set_gpr_idx_on s43, 0xc
    s_lshr_b64 s[42:43], s[42:43], 8
    v_mfma_f32_4x4x4_16b_bf16 v[156:159], v[8:9], v[40:41], v[156:159] cbsz:4 abid:9
    s_set_gpr_idx_on s42, 0xc
    ds_read_b64_tr_b16 v[12:13], v1 offset:4352
    v_mfma_f32_4x4x4_16b_bf16 v[156:159], v[8:9], v[42:43], v[156:159] cbsz:4 abid:10
    s_set_gpr_idx_on s43, 0xc
    s_lshr_b64 s[42:43], s[42:43], 8
    v_mfma_f32_4x4x4_16b_bf16 v[156:159], v[8:9], v[42:43], v[156:159] cbsz:4 abid:11
    s_set_gpr_idx_on s42, 0xc
    ds_read_b64_tr_b16 v[64:65], v1 offset:4608
    v_mfma_f32_4x4x4_16b_bf16 v[156:159], v[8:9], v[44:45], v[156:159] cbsz:4 abid:12
    s_set_gpr_idx_on s43, 0xc
    s_lshr_b64 s[42:43], s[42:43], 8
    v_mfma_f32_4x4x4_16b_bf16 v[156:159], v[8:9], v[44:45], v[156:159] cbsz:4 abid:13
    s_set_gpr_idx_on s42, 0xc
    ds_read_b64_tr_b16 v[66:67], v1 offset:4864
    v_mfma_f32_4x4x4_16b_bf16 v[156:159], v[8:9], v[46:47], v[156:159] cbsz:4 abid:14
    s_set_gpr_idx_on s43, 0xc
    ds_read_b64 v[48:49], v3 offset:10624
    v_mfma_f32_4x4x4_16b_bf16 v[156:159], v[8:9], v[46:47], v[156:159] cbsz:4 abid:15
    s_set_gpr_idx_off
    s_sub_u32 s39, s39, 1
    s_cbranch_scc1 tp_main_kernel_a_done
    s_setprio 2
    s_cmp_lt_u32 s3, 4
    s_cbranch_scc1 1
    s_setprio 3
    s_waitcnt lgkmcnt(1)
    v_mfma_f32_32x32x16_bf16 v[32:47], v[16:19], v[56:59], 0
    v_mad_u32_u16 v50, v50, s78, v14 op_sel:[1,0,0,0]
    s_add_u32 m0, s33, 3072
    v_mad_u32_u16 v51, v51, s78, v14 op_sel:[1,0,0,0]
    buffer_load_dwordx4 v50, s[4:7], s80 offen lds
    s_cmp_ge_i32 s39, 3
    s_cselect_b32 s80, s68, s69
    s_add_u32 m0, s33, 4096
    v_mfma_f32_32x32x16_bf16 v[32:47], v[20:23], v[60:63], v[32:47]
    buffer_load_dwordx4 v51, s[4:7], s80 offen lds
    s_add_u32 m0, s33, 7168
    v_bfi_b32 v53, 31, v0, v53
    buffer_load_dwordx4 v53, s[8:11], s80 offen lds
    s_nop 0
    s_waitcnt vmcnt(5) lgkmcnt(0)
    v_perm_b32 v8, v49, v48, v6
    v_mfma_f32_32x32x16_bf16 v[48:63], v[16:19], v[24:27], 0
    s_lshl_b64 s[40:41], s[44:45], 2
    s_lshl_b64 s[42:43], s[46:47], 2
    ds_read_b64_tr_b16 v[16:17], v1 offset:5120
    ds_read_b64_tr_b16 v[18:19], v1 offset:5376
    v_mul_f32 v32, v32, v10
    v_mul_f32 v33, v33, v11
    v_mul_f32 v34, v34, v12
    v_mul_f32 v35, v35, v13
    v_mfma_f32_32x32x16_bf16 v[48:63], v[20:23], v[28:31], v[48:63]
    ds_read_b64_tr_b16 v[20:21], v1 offset:5632
    ds_read_b64_tr_b16 v[22:23], v1 offset:5888
    v_mul_f32 v36, v36, v64
    v_mul_f32 v37, v37, v65
    v_mul_f32 v38, v38, v66
    v_mul_f32 v39, v39, v67
    v_cvt_pk_bf16_f32 v33, v32, v33
    v_cvt_pk_bf16_f32 v35, v34, v35
    v_cvt_pk_bf16_f32 v37, v36, v37
    v_cvt_pk_bf16_f32 v39, v38, v39
    s_waitcnt lgkmcnt(2)
    v_mul_f32 v40, v40, v16
    v_mul_f32 v41, v41, v17
    v_mul_f32 v42, v42, v18
    v_mul_f32 v43, v43, v19
    v_mul_f32 v48, v48, v10
    v_mul_f32 v49, v49, v11
    v_mul_f32 v50, v50, v12
    v_mul_f32 v51, v51, v13
    v_mul_f32 v52, v52, v64
    v_mul_f32 v53, v53, v65
    v_mul_f32 v54, v54, v66
    v_mul_f32 v55, v55, v67
    s_waitcnt lgkmcnt(0)
    s_buffer_load_dwordx4 s[44:47], s[88:91], s92
    s_add_u32 s92, s92, 16
    v_cvt_pk_bf16_f32 v32, v48, v49
    v_cvt_pk_bf16_f32 v34, v50, v51
    v_cvt_pk_bf16_f32 v36, v52, v53
    v_cvt_pk_bf16_f32 v38, v54, v55
    v_mul_f32 v44, v44, v20
    v_mul_f32 v45, v45, v21
    v_mul_f32 v46, v46, v22
    v_mul_f32 v47, v47, v23
    v_mul_f32 v56, v56, v16
    v_mul_f32 v57, v57, v17
    v_mul_f32 v58, v58, v18
    v_mul_f32 v59, v59, v19
    v_cvt_pk_bf16_f32 v41, v40, v41
    v_cvt_pk_bf16_f32 v43, v42, v43
    v_cvt_pk_bf16_f32 v45, v44, v45
    v_cvt_pk_bf16_f32 v47, v46, v47
    v_mul_f32 v60, v60, v20
    v_mul_f32 v61, v61, v21
    v_mul_f32 v62, v62, v22
    v_mul_f32 v63, v63, v23
    v_cvt_pk_bf16_f32 v40, v56, v57
    v_cvt_pk_bf16_f32 v42, v58, v59
    v_cvt_pk_bf16_f32 v44, v60, v61
    v_cvt_pk_bf16_f32 v46, v62, v63
    s_set_gpr_idx_on s40, 0xc
    ds_read2_b32 v[50:51], v2 offset0:80 offset1:96
    v_mfma_f32_4x4x4_16b_bf16 v[156:159], v[8:9], v[32:33], v[156:159] cbsz:4 abid:0
    s_set_gpr_idx_on s41, 0xc
    s_lshr_b64 s[40:41], s[40:41], 8
    v_mfma_f32_4x4x4_16b_bf16 v[156:159], v[8:9], v[32:33], v[156:159] cbsz:4 abid:1
    s_set_gpr_idx_on s40, 0xc
    ds_read_b128 v[56:59], v0 offset:0
    v_mfma_f32_4x4x4_16b_bf16 v[156:159], v[8:9], v[34:35], v[156:159] cbsz:4 abid:2
    s_set_gpr_idx_on s41, 0xc
    s_lshr_b64 s[40:41], s[40:41], 8
    v_mfma_f32_4x4x4_16b_bf16 v[156:159], v[8:9], v[34:35], v[156:159] cbsz:4 abid:3
    s_set_gpr_idx_on s40, 0xc
    ds_read_b128 v[60:63], v0 offset:1024
    v_mfma_f32_4x4x4_16b_bf16 v[156:159], v[8:9], v[36:37], v[156:159] cbsz:4 abid:4
    s_set_gpr_idx_on s41, 0xc
    s_lshr_b64 s[40:41], s[40:41], 8
    v_mfma_f32_4x4x4_16b_bf16 v[156:159], v[8:9], v[36:37], v[156:159] cbsz:4 abid:5
    s_set_gpr_idx_on s40, 0xc
    ds_read_b128 v[16:19], v5 offset:0
    v_mfma_f32_4x4x4_16b_bf16 v[156:159], v[8:9], v[38:39], v[156:159] cbsz:4 abid:6
    s_set_gpr_idx_on s41, 0xc
    ds_read_b128 v[20:23], v7 offset:0
    v_mfma_f32_4x4x4_16b_bf16 v[156:159], v[8:9], v[38:39], v[156:159] cbsz:4 abid:7
    s_set_gpr_idx_on s42, 0xc
    ds_read_b64_tr_b16 v[10:11], v1 offset:0
    v_mfma_f32_4x4x4_16b_bf16 v[156:159], v[8:9], v[40:41], v[156:159] cbsz:4 abid:8
    s_set_gpr_idx_on s43, 0xc
    s_lshr_b64 s[42:43], s[42:43], 8
    v_mfma_f32_4x4x4_16b_bf16 v[156:159], v[8:9], v[40:41], v[156:159] cbsz:4 abid:9
    s_set_gpr_idx_on s42, 0xc
    ds_read_b64_tr_b16 v[12:13], v1 offset:256
    v_mfma_f32_4x4x4_16b_bf16 v[156:159], v[8:9], v[42:43], v[156:159] cbsz:4 abid:10
    s_set_gpr_idx_on s43, 0xc
    s_lshr_b64 s[42:43], s[42:43], 8
    v_mfma_f32_4x4x4_16b_bf16 v[156:159], v[8:9], v[42:43], v[156:159] cbsz:4 abid:11
    s_set_gpr_idx_on s42, 0xc
    ds_read_b64_tr_b16 v[64:65], v1 offset:512
    v_mfma_f32_4x4x4_16b_bf16 v[156:159], v[8:9], v[44:45], v[156:159] cbsz:4 abid:12
    s_set_gpr_idx_on s43, 0xc
    s_lshr_b64 s[42:43], s[42:43], 8
    v_mfma_f32_4x4x4_16b_bf16 v[156:159], v[8:9], v[44:45], v[156:159] cbsz:4 abid:13
    s_set_gpr_idx_on s42, 0xc
    ds_read_b64_tr_b16 v[66:67], v1 offset:768
    v_mfma_f32_4x4x4_16b_bf16 v[156:159], v[8:9], v[46:47], v[156:159] cbsz:4 abid:14
    s_set_gpr_idx_on s43, 0xc
    ds_read_b64 v[48:49], v3 offset:10752
    v_mfma_f32_4x4x4_16b_bf16 v[156:159], v[8:9], v[46:47], v[156:159] cbsz:4 abid:15
    s_set_gpr_idx_off
    s_sub_u32 s39, s39, 1
    s_cbranch_scc1 tp_main_kernel_a_done
    s_branch tp_main_kernel_a_loop
tp_main_kernel_a_done:
    s_setprio 2
    s_waitcnt lgkmcnt(0)
    v_mov_b32 v7, 10368
    v_lshrrev_b32 v16, 4, v0
    v_mul_u32_u24 v1, 56, v16
    v_add_u32 v1, s33, v1
    v_lshrrev_b32 v17, 5, v16
    v_bfe_u32 v18, v16, 2, 2
    v_lshl_add_u32 v18, v17, 3, v18
    v_mul_u32_u24 v2, 56, v18
    v_bfe_u32 v18, v16, 4, 1
    v_lshl_add_u32 v2, v18, 5, v2
    v_and_b32 v18, 3, v16
    v_lshl_add_u32 v2, v18, 3, v2
    v_add_u32 v2, s33, v2
    v_add_u32 v3, 64512, v0
    v_add_u32 v4, 131712, v0
    v_and_b32 v18, 31, v16
    v_lshlrev_b32 v18, 2, v18
    s_lshl_b32 s48, s32, 9
    v_add_u32 v5, s48, v18
    s_lshl_b32 s48, s3, 5
    v_lshl_add_u32 v6, v17, 2, s48
    s_add_u32 s50, s34, s36
    s_cmp_ge_u32 s50, s35
    s_cselect_b32 s18, 25600000, 0
    s_lshl_b32 s51, s2, 3
    s_add_u32 s51, s51, s3
    s_lshl_b32 s51, s51, 15
tp_main_kernel_spin:
    ds_read_b32 v17, v7
    s_waitcnt lgkmcnt(0)
    v_readfirstlane_b32 s48, v17
    s_cmp_lt_u32 s48, 8
    s_cbranch_scc1 tp_main_kernel_spin
    s_waitcnt vmcnt(0)
    ds_write_b64 v1, v[68:69] offset:0
    ds_write_b64 v1, v[70:71] offset:8
    ds_write_b64 v1, v[72:73] offset:16
    ds_write_b64 v1, v[74:75] offset:24
    ds_write_b64 v1, v[76:77] offset:32
    ds_write_b64 v1, v[78:79] offset:40
    ds_write_b16_d16_hi v1, v153 offset:48
    ds_read_b64_tr_b16 v[8:9], v2 offset:0
    ds_read_b64_tr_b16 v[10:11], v2 offset:224
    ds_read_b128 v[24:27], v3 offset:16512
    ds_read_b128 v[28:31], v3 offset:17536
    ds_read_b64_tr_b16 v[12:13], v2 offset:896
    ds_read_b64_tr_b16 v[14:15], v2 offset:1120
    ds_read_b128 v[32:35], v3 offset:26880
    ds_read_b128 v[36:39], v3 offset:27904
    v_cvt_pk_bf16_f32 v158, v158, v162
    v_cvt_pk_bf16_f32 v162, v190, v194
    v_cvt_pk_bf16_f32 v194, v159, v163
    v_cvt_pk_bf16_f32 v159, v166, v170
    v_cvt_pk_bf16_f32 v170, v157, v161
    v_cvt_pk_bf16_f32 v161, v182, v186
    v_cvt_pk_bf16_f32 v182, v156, v160
    v_cvt_pk_bf16_f32 v160, v174, v178
    v_cvt_pk_bf16_f32 v186, v188, v192
    v_cvt_pk_bf16_f32 v174, v189, v193
    v_cvt_pk_bf16_f32 v163, v198, v202
    v_cvt_pk_bf16_f32 v198, v191, v195
    v_cvt_pk_bf16_f32 v195, v167, v171
    v_cvt_pk_bf16_f32 v171, v165, v169
    v_cvt_pk_bf16_f32 v199, v199, v203
    v_cvt_pk_bf16_f32 v188, v204, v208
    v_cvt_pk_bf16_f32 v189, v212, v216
    v_cvt_pk_bf16_f32 v165, v214, v218
    v_cvt_pk_bf16_f32 v190, v220, v224
    v_cvt_pk_bf16_f32 v178, v221, v225
    v_cvt_pk_bf16_f32 v166, v222, v226
    v_cvt_pk_bf16_f32 v202, v223, v227
    v_cvt_pk_bf16_f32 v191, v228, v232
    v_cvt_pk_bf16_f32 v167, v230, v234
    v_cvt_pk_bf16_f32 v203, v231, v235
    v_cvt_pk_bf16_f32 v192, v236, v240
    v_cvt_pk_bf16_f32 v204, v239, v243
    v_cvt_pk_bf16_f32 v193, v244, v248
    v_cvt_pk_bf16_f32 v169, v246, v250
    v_cvt_pk_bf16_f32 v156, v252, v253
    v_cvt_pk_bf16_f32 v157, v254, v255
    v_cvt_pk_bf16_f32 v67, v164, v168
    v_cvt_pk_bf16_f32 v164, v206, v210
    v_cvt_pk_bf16_f32 v168, v238, v242
    v_cvt_pk_bf16_f32 v66, v172, v176
    v_cvt_pk_bf16_f32 v172, v173, v177
    v_cvt_pk_bf16_f32 v173, v181, v185
    v_cvt_pk_bf16_f32 v185, v180, v184
    v_cvt_pk_bf16_f32 v176, v205, v209
    v_cvt_pk_bf16_f32 v177, v213, v217
    v_cvt_pk_bf16_f32 v180, v237, v241
    v_cvt_pk_bf16_f32 v181, v245, v249
    v_cvt_pk_bf16_f32 v205, v247, v251
    v_cvt_pk_bf16_f32 v65, v175, v179
    v_cvt_pk_bf16_f32 v175, v197, v201
    v_cvt_pk_bf16_f32 v197, v183, v187
    v_cvt_pk_bf16_f32 v187, v196, v200
    v_cvt_pk_bf16_f32 v200, v207, v211
    v_cvt_pk_bf16_f32 v201, v215, v219
    v_cvt_pk_bf16_f32 v179, v229, v233
    v_mov_b32 v183, v67
    v_mov_b32 v184, v66
    v_mov_b32 v196, v65
    s_waitcnt lgkmcnt(4)
    v_mfma_f32_32x32x16_bf16 v[224:239], v[8:11], v[24:27], 0
    ds_write_b64 v1, v[194:195] offset:3584
    ds_write_b64 v1, v[196:197] offset:3592
    ds_write_b64 v1, v[198:199] offset:3600
    ds_write_b64 v1, v[200:201] offset:3608
    v_mfma_f32_32x32x16_bf16 v[240:255], v[8:11], v[28:31], 0
    ds_read_b64_tr_b16 v[16:17], v2 offset:1792
    ds_read_b64_tr_b16 v[18:19], v2 offset:2016
    ds_read_b128 v[40:43], v3 offset:28928
    ds_read_b128 v[44:47], v3 offset:29952
    s_waitcnt lgkmcnt(8)
    v_mfma_f32_32x32x16_bf16 v[224:239], v[12:15], v[32:35], v[224:239]
    ds_write_b64 v1, v[202:203] offset:3616
    ds_write_b64 v1, v[204:205] offset:3624
    ds_write_b16_d16_hi v1, v157 offset:3632
    ds_read_b64_tr_b16 v[20:21], v2 offset:2688
    v_mfma_f32_32x32x16_bf16 v[240:255], v[12:15], v[36:39], v[240:255]
    ds_read_b64_tr_b16 v[22:23], v2 offset:2912
    ds_read_b128 v[48:51], v3 offset:30976
    ds_read_b128 v[52:55], v3 offset:40320
    s_waitcnt lgkmcnt(7)
    v_mfma_f32_32x32x16_bf16 v[224:239], v[16:19], v[40:43], v[224:239]
    ds_read_b64_tr_b16 v[8:9], v2 offset:3584
    ds_read_b64_tr_b16 v[10:11], v2 offset:3808
    ds_read_b128 v[24:27], v3 offset:0
    ds_read_b128 v[28:31], v3 offset:1024
    ds_read_u8 v60, v6 offset:10496
    ds_read_u8 v61, v6 offset:10497
    ds_read_u8 v62, v6 offset:10498
    ds_read_u8 v63, v6 offset:10499
    ds_read_u8 v64, v6 offset:10504
    v_mfma_f32_32x32x16_bf16 v[240:255], v[16:19], v[44:47], v[240:255]
    ds_read_u8 v65, v6 offset:10505
    ds_read_u8 v66, v6 offset:10506
    ds_read_u8 v67, v6 offset:10507
    ds_read_u8 v68, v6 offset:10512
    ds_read_u8 v69, v6 offset:10513
    ds_read_u8 v70, v6 offset:10514
    ds_read_u8 v71, v6 offset:10515
    ds_read_u8 v72, v6 offset:10520
    s_waitcnt lgkmcnt(15)
    v_mfma_f32_32x32x16_bf16 v[224:239], v[20:23], v[48:51], v[224:239]
    ds_read_b64_tr_b16 v[12:13], v2 offset:4480
    ds_read_b64_tr_b16 v[14:15], v2 offset:4704
    v_mfma_f32_32x32x16_bf16 v[240:255], v[20:23], v[52:55], v[240:255]
    ds_read_b128 v[32:35], v3 offset:2048
    ds_read_b128 v[36:39], v3 offset:3072
    s_waitcnt lgkmcnt(15)
    v_mfma_f32_32x32x16_bf16 v[224:239], v[8:11], v[24:27], v[224:239]
    ds_write_b64 v1, v[182:183] offset:0
    ds_write_b64 v1, v[184:185] offset:8
    ds_write_b64 v1, v[186:187] offset:16
    ds_write_b64 v1, v[188:189] offset:24
    v_mfma_f32_32x32x16_bf16 v[240:255], v[8:11], v[28:31], v[240:255]
    ds_read_b64_tr_b16 v[16:17], v2 offset:5376
    ds_read_b64_tr_b16 v[18:19], v2 offset:5600
    ds_read_b128 v[40:43], v3 offset:4096
    ds_read_b128 v[44:47], v3 offset:13440
    s_waitcnt lgkmcnt(8)
    v_mfma_f32_32x32x16_bf16 v[224:239], v[12:15], v[32:35], v[224:239]
    ds_write_b64 v1, v[190:191] offset:32
    ds_write_b64 v1, v[192:193] offset:40
    ds_write_b16 v1, v156 offset:48
    ds_read_b64_tr_b16 v[20:21], v2 offset:6272
    v_mfma_f32_32x32x16_bf16 v[240:255], v[12:15], v[36:39], v[240:255]
    ds_read_b64_tr_b16 v[22:23], v2 offset:6496
    ds_read_b128 v[48:51], v3 offset:14464
    ds_read_b128 v[52:55], v3 offset:15488
    s_waitcnt lgkmcnt(7)
    v_mfma_f32_32x32x16_bf16 v[224:239], v[16:19], v[40:43], v[224:239]
    ds_read_b64_tr_b16 v[8:9], v2 offset:0
    ds_read_b64_tr_b16 v[10:11], v2 offset:224
    v_lshl_add_u32 v60, v60, 17, v5
    v_lshl_add_u32 v61, v61, 17, v5
    v_lshl_add_u32 v62, v62, 17, v5
    v_lshl_add_u32 v63, v63, 17, v5
    v_lshl_add_u32 v64, v64, 17, v5
    v_mfma_f32_32x32x16_bf16 v[240:255], v[16:19], v[44:47], v[240:255]
    ds_read_b128 v[24:27], v3 offset:41344
    ds_read_b128 v[28:31], v3 offset:42368
    v_lshl_add_u32 v65, v65, 17, v5
    v_lshl_add_u32 v66, v66, 17, v5
    v_lshl_add_u32 v67, v67, 17, v5
    v_lshl_add_u32 v68, v68, 17, v5
    v_lshl_add_u32 v69, v69, 17, v5
    s_waitcnt lgkmcnt(4)
    v_mfma_f32_32x32x16_bf16 v[224:239], v[20:23], v[48:51], v[224:239]
    ds_read_b64_tr_b16 v[12:13], v2 offset:896
    ds_read_b64_tr_b16 v[14:15], v2 offset:1120
    v_lshl_add_u32 v70, v70, 17, v5
    v_lshl_add_u32 v71, v71, 17, v5
    v_lshl_add_u32 v72, v72, 17, v5
    v_mfma_f32_32x32x16_bf16 v[240:255], v[20:23], v[52:55], v[240:255]
    ds_read_b128 v[32:35], v3 offset:43392
    ds_read_b128 v[36:39], v3 offset:44416
    s_cmp_lg_u32 s35, s36
    s_cbranch_scc1 tp_main_kernel_multi0
tp_main_kernel_fin0:
    s_waitcnt lgkmcnt(4)
    v_mfma_f32_32x32x16_bf16 v[192:207], v[8:11], v[24:27], 0
    ds_write_b64 v1, v[80:81] offset:3584
    ds_write_b64 v1, v[82:83] offset:3592
    ds_write_b64 v1, v[84:85] offset:3600
    ds_write_b64 v1, v[86:87] offset:3608
    v_mfma_f32_32x32x16_bf16 v[208:223], v[8:11], v[28:31], 0
    ds_read_b64_tr_b16 v[16:17], v2 offset:1792
    ds_read_b64_tr_b16 v[18:19], v2 offset:2016
    ds_read_b128 v[40:43], v3 offset:53760
    ds_read_b128 v[44:47], v3 offset:54784
    s_waitcnt lgkmcnt(8)
    v_mfma_f32_32x32x16_bf16 v[192:207], v[12:15], v[32:35], v[192:207]
    ds_write_b64 v1, v[88:89] offset:3616
    ds_write_b64 v1, v[90:91] offset:3624
    ds_write_b16 v1, v154 offset:3632
    ds_read_b64_tr_b16 v[20:21], v2 offset:2688
    v_cvt_pk_bf16_f32 v56, v224, v240
    v_mul_f32 v224, 0xbfb8aa3b, v224
    v_mul_f32 v240, 0xbfb8aa3b, v240
    v_exp_f32 v224, v224
    v_exp_f32 v240, v240
    v_mfma_f32_32x32x16_bf16 v[208:223], v[12:15], v[36:39], v[208:223]
    ds_read_b64_tr_b16 v[22:23], v2 offset:2912
    ds_read_b128 v[48:51], v3 offset:55808
    ds_read_b128 v[52:55], v3 offset:56832
    buffer_store_dword v56, v60, s[16:19], 0 offen offset:0 sc1
    v_add_f32 v224, 1.0, v224
    v_add_f32 v240, 1.0, v240
    v_rcp_f32 v224, v224
    v_rcp_f32 v240, v240
    s_waitcnt lgkmcnt(7)
    v_mfma_f32_32x32x16_bf16 v[192:207], v[16:19], v[40:43], v[192:207]
    ds_read_b64_tr_b16 v[8:9], v2 offset:3584
    ds_read_b64_tr_b16 v[10:11], v2 offset:3808
    v_cvt_pk_bf16_f32 v57, v225, v241
    v_mul_f32 v225, 0xbfb8aa3b, v225
    v_mul_f32 v241, 0xbfb8aa3b, v241
    v_exp_f32 v225, v225
    v_exp_f32 v241, v241
    v_mfma_f32_32x32x16_bf16 v[208:223], v[16:19], v[44:47], v[208:223]
    ds_read_b128 v[24:27], v3 offset:57856
    ds_read_b128 v[28:31], v4 offset:0
    buffer_store_dword v57, v61, s[16:19], 0 offen offset:0 sc1
    v_add_f32 v225, 1.0, v225
    v_add_f32 v241, 1.0, v241
    v_rcp_f32 v225, v225
    v_rcp_f32 v241, v241
    s_waitcnt lgkmcnt(4)
    v_mfma_f32_32x32x16_bf16 v[192:207], v[20:23], v[48:51], v[192:207]
    ds_read_b64_tr_b16 v[12:13], v2 offset:4480
    ds_read_b64_tr_b16 v[14:15], v2 offset:4704
    v_cvt_pk_bf16_f32 v58, v226, v242
    v_mul_f32 v226, 0xbfb8aa3b, v226
    v_mul_f32 v242, 0xbfb8aa3b, v242
    v_exp_f32 v226, v226
    v_exp_f32 v242, v242
    v_mfma_f32_32x32x16_bf16 v[208:223], v[20:23], v[52:55], v[208:223]
    ds_read_b128 v[32:35], v4 offset:1024
    ds_read_b128 v[36:39], v4 offset:2048
    buffer_store_dword v58, v62, s[16:19], 0 offen offset:0 sc1
    v_add_f32 v226, 1.0, v226
    v_add_f32 v242, 1.0, v242
    v_rcp_f32 v226, v226
    v_rcp_f32 v242, v242
    s_waitcnt lgkmcnt(4)
    v_mfma_f32_32x32x16_bf16 v[192:207], v[8:11], v[24:27], v[192:207]
    ds_write_b64 v1, v[92:93] offset:0
    ds_write_b64 v1, v[94:95] offset:8
    ds_write_b64 v1, v[96:97] offset:16
    ds_write_b64 v1, v[98:99] offset:24
    v_cvt_pk_bf16_f32 v59, v227, v243
    v_mul_f32 v227, 0xbfb8aa3b, v227
    v_mul_f32 v243, 0xbfb8aa3b, v243
    v_exp_f32 v227, v227
    v_exp_f32 v243, v243
    v_mfma_f32_32x32x16_bf16 v[208:223], v[8:11], v[28:31], v[208:223]
    ds_read_b64_tr_b16 v[16:17], v2 offset:5376
    ds_read_b64_tr_b16 v[18:19], v2 offset:5600
    ds_read_b128 v[40:43], v4 offset:3072
    ds_read_b128 v[44:47], v4 offset:4096
    buffer_store_dword v59, v63, s[16:19], 0 offen offset:0 sc1
    v_add_f32 v227, 1.0, v227
    v_add_f32 v243, 1.0, v243
    v_rcp_f32 v227, v227
    v_rcp_f32 v243, v243
    s_waitcnt lgkmcnt(8)
    v_mfma_f32_32x32x16_bf16 v[192:207], v[12:15], v[32:35], v[192:207]
    ds_write_b64 v1, v[100:101] offset:32
    ds_write_b64 v1, v[102:103] offset:40
    ds_write_b16 v1, v152 offset:48
    ds_read_b64_tr_b16 v[20:21], v2 offset:6272
    v_cvt_pk_bf16_f32 v56, v228, v244
    v_mul_f32 v228, 0xbfb8aa3b, v228
    v_mul_f32 v244, 0xbfb8aa3b, v244
    v_exp_f32 v228, v228
    v_exp_f32 v244, v244
    v_mfma_f32_32x32x16_bf16 v[208:223], v[12:15], v[36:39], v[208:223]
    ds_read_b64_tr_b16 v[22:23], v2 offset:6496
    ds_read_b128 v[48:51], v4 offset:13440
    ds_read_b128 v[52:55], v4 offset:14464
    buffer_store_dword v56, v64, s[16:19], 0 offen offset:0 sc1
    v_add_f32 v228, 1.0, v228
    v_add_f32 v244, 1.0, v244
    v_rcp_f32 v228, v228
    v_rcp_f32 v244, v244
    s_waitcnt lgkmcnt(7)
    v_mfma_f32_32x32x16_bf16 v[192:207], v[16:19], v[40:43], v[192:207]
    ds_read_b64_tr_b16 v[8:9], v2 offset:0
    ds_read_b64_tr_b16 v[10:11], v2 offset:224
    v_cvt_pk_bf16_f32 v57, v229, v245
    v_mul_f32 v229, 0xbfb8aa3b, v229
    v_mul_f32 v245, 0xbfb8aa3b, v245
    v_exp_f32 v229, v229
    v_exp_f32 v245, v245
    v_mfma_f32_32x32x16_bf16 v[208:223], v[16:19], v[44:47], v[208:223]
    ds_read_b128 v[24:27], v4 offset:15488
    ds_read_b128 v[28:31], v4 offset:16512
    buffer_store_dword v57, v65, s[16:19], 0 offen offset:0 sc1
    v_add_f32 v229, 1.0, v229
    v_add_f32 v245, 1.0, v245
    v_rcp_f32 v229, v229
    v_rcp_f32 v245, v245
    s_waitcnt lgkmcnt(4)
    v_mfma_f32_32x32x16_bf16 v[192:207], v[20:23], v[48:51], v[192:207]
    ds_read_b64_tr_b16 v[12:13], v2 offset:896
    ds_read_b64_tr_b16 v[14:15], v2 offset:1120
    v_cvt_pk_bf16_f32 v58, v230, v246
    v_mul_f32 v230, 0xbfb8aa3b, v230
    v_mul_f32 v246, 0xbfb8aa3b, v246
    v_exp_f32 v230, v230
    v_exp_f32 v246, v246
    v_mfma_f32_32x32x16_bf16 v[208:223], v[20:23], v[52:55], v[208:223]
    ds_read_b128 v[32:35], v4 offset:17536
    ds_read_b128 v[36:39], v4 offset:26880
    buffer_store_dword v58, v66, s[16:19], 0 offen offset:0 sc1
    v_add_f32 v230, 1.0, v230
    v_add_f32 v246, 1.0, v246
    v_rcp_f32 v230, v230
    v_rcp_f32 v246, v246
    s_waitcnt lgkmcnt(4)
    v_mfma_f32_32x32x16_bf16 v[192:207], v[8:11], v[24:27], v[192:207]
    ds_write_b64 v1, v[170:171] offset:3584
    ds_write_b64 v1, v[172:173] offset:3592
    ds_write_b64 v1, v[174:175] offset:3600
    ds_write_b64 v1, v[176:177] offset:3608
    v_cvt_pk_bf16_f32 v59, v231, v247
    v_mul_f32 v231, 0xbfb8aa3b, v231
    v_mul_f32 v247, 0xbfb8aa3b, v247
    v_exp_f32 v231, v231
    v_exp_f32 v247, v247
    v_mfma_f32_32x32x16_bf16 v[208:223], v[8:11], v[28:31], v[208:223]
    ds_read_b64_tr_b16 v[16:17], v2 offset:1792
    ds_read_b64_tr_b16 v[18:19], v2 offset:2016
    ds_read_b128 v[40:43], v4 offset:27904
    ds_read_b128 v[44:47], v4 offset:28928
    buffer_store_dword v59, v67, s[16:19], 0 offen offset:0 sc1
    v_add_f32 v231, 1.0, v231
    v_add_f32 v247, 1.0, v247
    v_rcp_f32 v231, v231
    v_rcp_f32 v247, v247
    s_waitcnt lgkmcnt(8)
    v_mfma_f32_32x32x16_bf16 v[192:207], v[12:15], v[32:35], v[192:207]
    ds_write_b64 v1, v[178:179] offset:3616
    ds_write_b64 v1, v[180:181] offset:3624
    ds_write_b16_d16_hi v1, v156 offset:3632
    ds_read_b64_tr_b16 v[20:21], v2 offset:2688
    v_cvt_pk_bf16_f32 v56, v232, v248
    v_mul_f32 v232, 0xbfb8aa3b, v232
    v_mul_f32 v248, 0xbfb8aa3b, v248
    v_exp_f32 v232, v232
    v_exp_f32 v248, v248
    v_mfma_f32_32x32x16_bf16 v[208:223], v[12:15], v[36:39], v[208:223]
    ds_read_b64_tr_b16 v[22:23], v2 offset:2912
    ds_read_b128 v[48:51], v4 offset:29952
    ds_read_b128 v[52:55], v4 offset:30976
    buffer_store_dword v56, v68, s[16:19], 0 offen offset:0 sc1
    v_add_f32 v232, 1.0, v232
    v_add_f32 v248, 1.0, v248
    v_rcp_f32 v232, v232
    v_rcp_f32 v248, v248
    s_setprio 1
    s_cmp_lt_u32 s3, 4
    s_cbranch_scc1 1
    s_setprio 2
    s_waitcnt lgkmcnt(7)
    v_mfma_f32_32x32x16_bf16 v[192:207], v[16:19], v[40:43], v[192:207]
    ds_read_b64_tr_b16 v[8:9], v2 offset:3584
    ds_read_b64_tr_b16 v[10:11], v2 offset:3808
    v_cvt_pk_bf16_f32 v57, v233, v249
    v_mul_f32 v233, 0xbfb8aa3b, v233
    v_mul_f32 v249, 0xbfb8aa3b, v249
    v_exp_f32 v233, v233
    v_exp_f32 v249, v249
    v_mfma_f32_32x32x16_bf16 v[208:223], v[16:19], v[44:47], v[208:223]
    ds_read_b128 v[24:27], v3 offset:41344
    ds_read_b128 v[28:31], v3 offset:42368
    buffer_store_dword v57, v69, s[16:19], 0 offen offset:0 sc1
    v_add_f32 v233, 1.0, v233
    v_add_f32 v249, 1.0, v249
    v_rcp_f32 v233, v233
    v_rcp_f32 v249, v249
    s_waitcnt lgkmcnt(4)
    v_mfma_f32_32x32x16_bf16 v[192:207], v[20:23], v[48:51], v[192:207]
    ds_read_b64_tr_b16 v[12:13], v2 offset:4480
    ds_read_b64_tr_b16 v[14:15], v2 offset:4704
    v_cvt_pk_bf16_f32 v58, v234, v250
    v_mul_f32 v234, 0xbfb8aa3b, v234
    v_mul_f32 v250, 0xbfb8aa3b, v250
    v_exp_f32 v234, v234
    v_exp_f32 v250, v250
    v_mfma_f32_32x32x16_bf16 v[208:223], v[20:23], v[52:55], v[208:223]
    ds_read_b128 v[32:35], v3 offset:43392
    ds_read_b128 v[36:39], v3 offset:44416
    buffer_store_dword v58, v70, s[16:19], 0 offen offset:0 sc1
    v_add_f32 v234, 1.0, v234
    v_add_f32 v250, 1.0, v250
    v_rcp_f32 v234, v234
    v_rcp_f32 v250, v250
    v_cvt_pk_bf16_f32 v59, v235, v251
    v_mul_f32 v235, 0xbfb8aa3b, v235
    v_mul_f32 v251, 0xbfb8aa3b, v251
    v_exp_f32 v235, v235
    v_exp_f32 v251, v251
    buffer_store_dword v59, v71, s[16:19], 0 offen offset:0 sc1
    v_add_f32 v235, 1.0, v235
    v_add_f32 v251, 1.0, v251
    v_rcp_f32 v235, v235
    v_rcp_f32 v251, v251
    v_cvt_pk_bf16_f32 v56, v236, v252
    v_mul_f32 v236, 0xbfb8aa3b, v236
    v_mul_f32 v252, 0xbfb8aa3b, v252
    v_exp_f32 v236, v236
    v_exp_f32 v252, v252
    buffer_store_dword v56, v72, s[16:19], 0 offen offset:0 sc1
    v_add_f32 v236, 1.0, v236
    v_add_f32 v252, 1.0, v252
    v_rcp_f32 v236, v236
    v_rcp_f32 v252, v252
    s_cmp_lg_u32 s35, s36
    s_cbranch_scc1 tp_main_kernel_multi1
tp_main_kernel_fin1:
    s_waitcnt lgkmcnt(4)
    v_mfma_f32_32x32x16_bf16 v[74:89], v[8:11], v[24:27], 0
    ds_write_b64 v1, v[104:105] offset:0
    ds_write_b64 v1, v[106:107] offset:8
    ds_write_b64 v1, v[108:109] offset:16
    ds_write_b64 v1, v[110:111] offset:24
    v_mfma_f32_32x32x16_bf16 v[176:191], v[8:11], v[28:31], 0
    ds_read_b64_tr_b16 v[16:17], v2 offset:5376
    ds_read_b64_tr_b16 v[18:19], v2 offset:5600
    ds_read_b128 v[40:43], v3 offset:53760
    ds_read_b128 v[44:47], v3 offset:54784
    s_waitcnt lgkmcnt(8)
    v_mfma_f32_32x32x16_bf16 v[74:89], v[12:15], v[32:35], v[74:89]
    ds_write_b64 v1, v[112:113] offset:32
    ds_write_b64 v1, v[114:115] offset:40
    ds_write_b16_d16_hi v1, v154 offset:48
    ds_read_b64_tr_b16 v[20:21], v2 offset:6272
    v_mul_f32 v192, v192, v224
    v_mul_f32 v208, v208, v240
    v_cvt_pk_bf16_f32 v56, v192, v208
    buffer_store_dword v56, v60, s[16:19], 0 offen offset:128 sc1
    v_mul_f32 v193, v193, v225
    v_mfma_f32_32x32x16_bf16 v[176:191], v[12:15], v[36:39], v[176:191]
    ds_read_b64_tr_b16 v[22:23], v2 offset:6496
    ds_read_b128 v[48:51], v3 offset:55808
    ds_read_b128 v[52:55], v3 offset:56832
    v_mul_f32 v209, v209, v241
    v_cvt_pk_bf16_f32 v57, v193, v209
    buffer_store_dword v57, v61, s[16:19], 0 offen offset:128 sc1
    v_mul_f32 v194, v194, v226
    v_mul_f32 v210, v210, v242
    s_waitcnt lgkmcnt(7)
    v_mfma_f32_32x32x16_bf16 v[74:89], v[16:19], v[40:43], v[74:89]
    ds_read_b64_tr_b16 v[8:9], v2 offset:0
    ds_read_b64_tr_b16 v[10:11], v2 offset:224
    v_cvt_pk_bf16_f32 v58, v194, v210
    buffer_store_dword v58, v62, s[16:19], 0 offen offset:128 sc1
    v_mul_f32 v195, v195, v227
    v_mul_f32 v211, v211, v243
    v_cvt_pk_bf16_f32 v59, v195, v211
    v_mfma_f32_32x32x16_bf16 v[176:191], v[16:19], v[44:47], v[176:191]
    ds_read_b128 v[24:27], v3 offset:57856
    ds_read_b128 v[28:31], v4 offset:0
    buffer_store_dword v59, v63, s[16:19], 0 offen offset:128 sc1
    v_mul_f32 v196, v196, v228
    v_mul_f32 v212, v212, v244
    v_cvt_pk_bf16_f32 v56, v196, v212
    buffer_store_dword v56, v64, s[16:19], 0 offen offset:128 sc1
    s_waitcnt lgkmcnt(4)
    v_mfma_f32_32x32x16_bf16 v[74:89], v[20:23], v[48:51], v[74:89]
    ds_read_b64_tr_b16 v[12:13], v2 offset:896
    ds_read_b64_tr_b16 v[14:15], v2 offset:1120
    v_mul_f32 v197, v197, v229
    v_mul_f32 v213, v213, v245
    v_cvt_pk_bf16_f32 v57, v197, v213
    buffer_store_dword v57, v65, s[16:19], 0 offen offset:128 sc1
    v_mul_f32 v198, v198, v230
    v_mfma_f32_32x32x16_bf16 v[176:191], v[20:23], v[52:55], v[176:191]
    ds_read_b128 v[32:35], v4 offset:1024
    ds_read_b128 v[36:39], v4 offset:2048
    v_mul_f32 v214, v214, v246
    v_cvt_pk_bf16_f32 v58, v198, v214
    buffer_store_dword v58, v66, s[16:19], 0 offen offset:128 sc1
    v_mul_f32 v199, v199, v231
    v_mul_f32 v215, v215, v247
    s_waitcnt lgkmcnt(4)
    v_mfma_f32_32x32x16_bf16 v[74:89], v[8:11], v[24:27], v[74:89]
    ds_write_b64 v1, v[116:117] offset:3584
    ds_write_b64 v1, v[118:119] offset:3592
    ds_write_b64 v1, v[120:121] offset:3600
    ds_write_b64 v1, v[122:123] offset:3608
    v_cvt_pk_bf16_f32 v59, v199, v215
    buffer_store_dword v59, v67, s[16:19], 0 offen offset:128 sc1
    v_mul_f32 v200, v200, v232
    v_mul_f32 v216, v216, v248
    v_cvt_pk_bf16_f32 v56, v200, v216
    v_mfma_f32_32x32x16_bf16 v[176:191], v[8:11], v[28:31], v[176:191]
    ds_read_b64_tr_b16 v[16:17], v2 offset:1792
    ds_read_b64_tr_b16 v[18:19], v2 offset:2016
    ds_read_b128 v[40:43], v4 offset:3072
    ds_read_b128 v[44:47], v4 offset:4096
    buffer_store_dword v56, v68, s[16:19], 0 offen offset:128 sc1
    v_mul_f32 v201, v201, v233
    v_mul_f32 v217, v217, v249
    v_cvt_pk_bf16_f32 v57, v201, v217
    buffer_store_dword v57, v69, s[16:19], 0 offen offset:128 sc1
    s_waitcnt lgkmcnt(8)
    v_mfma_f32_32x32x16_bf16 v[74:89], v[12:15], v[32:35], v[74:89]
    ds_write_b64 v1, v[124:125] offset:3616
    ds_write_b64 v1, v[126:127] offset:3624
    ds_write_b16_d16_hi v1, v152 offset:3632
    ds_read_b64_tr_b16 v[20:21], v2 offset:2688
    v_mul_f32 v202, v202, v234
    v_mul_f32 v218, v218, v250
    v_cvt_pk_bf16_f32 v58, v202, v218
    buffer_store_dword v58, v70, s[16:19], 0 offen offset:128 sc1
    v_mul_f32 v203, v203, v235
    v_mfma_f32_32x32x16_bf16 v[176:191], v[12:15], v[36:39], v[176:191]
    ds_read_b64_tr_b16 v[22:23], v2 offset:2912
    ds_read_b128 v[48:51], v4 offset:13440
    ds_read_b128 v[52:55], v4 offset:14464
    v_mul_f32 v219, v219, v251
    v_cvt_pk_bf16_f32 v59, v203, v219
    buffer_store_dword v59, v71, s[16:19], 0 offen offset:128 sc1
    v_mul_f32 v204, v204, v236
    v_mul_f32 v220, v220, v252
    s_waitcnt lgkmcnt(7)
    v_mfma_f32_32x32x16_bf16 v[74:89], v[16:19], v[40:43], v[74:89]
    ds_read_b64_tr_b16 v[8:9], v2 offset:3584
    ds_read_b64_tr_b16 v[10:11], v2 offset:3808
    v_cvt_pk_bf16_f32 v56, v204, v220
    buffer_store_dword v56, v72, s[16:19], 0 offen offset:128 sc1
    v_mfma_f32_32x32x16_bf16 v[176:191], v[16:19], v[44:47], v[176:191]
    ds_read_b128 v[24:27], v4 offset:15488
    ds_read_b128 v[28:31], v4 offset:16512
    s_waitcnt lgkmcnt(4)
    v_mfma_f32_32x32x16_bf16 v[74:89], v[20:23], v[48:51], v[74:89]
    ds_read_b64_tr_b16 v[12:13], v2 offset:4480
    ds_read_b64_tr_b16 v[14:15], v2 offset:4704
    v_mfma_f32_32x32x16_bf16 v[176:191], v[20:23], v[52:55], v[176:191]
    ds_read_b128 v[32:35], v4 offset:17536
    ds_read_b128 v[36:39], v4 offset:26880
    s_waitcnt lgkmcnt(4)
    v_mfma_f32_32x32x16_bf16 v[74:89], v[8:11], v[24:27], v[74:89]
    ds_write_b64 v1, v[158:159] offset:0
    ds_write_b64 v1, v[160:161] offset:8
    ds_write_b64 v1, v[162:163] offset:16
    ds_write_b64 v1, v[164:165] offset:24
    v_mfma_f32_32x32x16_bf16 v[176:191], v[8:11], v[28:31], v[176:191]
    ds_read_b64_tr_b16 v[16:17], v2 offset:5376
    ds_read_b64_tr_b16 v[18:19], v2 offset:5600
    ds_read_b128 v[40:43], v4 offset:27904
    ds_read_b128 v[44:47], v4 offset:28928
    s_waitcnt lgkmcnt(8)
    v_mfma_f32_32x32x16_bf16 v[74:89], v[12:15], v[32:35], v[74:89]
    ds_write_b64 v1, v[166:167] offset:32
    ds_write_b64 v1, v[168:169] offset:40
    ds_write_b16 v1, v157 offset:48
    ds_read_b64_tr_b16 v[20:21], v2 offset:6272
    v_mfma_f32_32x32x16_bf16 v[176:191], v[12:15], v[36:39], v[176:191]
    ds_read_b64_tr_b16 v[22:23], v2 offset:6496
    ds_read_b128 v[48:51], v4 offset:29952
    ds_read_b128 v[52:55], v4 offset:30976
    s_setprio 1
    s_waitcnt lgkmcnt(7)
    v_mfma_f32_32x32x16_bf16 v[74:89], v[16:19], v[40:43], v[74:89]
    ds_read_b64_tr_b16 v[8:9], v2 offset:0
    ds_read_b64_tr_b16 v[10:11], v2 offset:224
    v_mfma_f32_32x32x16_bf16 v[176:191], v[16:19], v[44:47], v[176:191]
    ds_read_b128 v[24:27], v3 offset:41344
    ds_read_b128 v[28:31], v3 offset:42368
    s_waitcnt lgkmcnt(4)
    v_mfma_f32_32x32x16_bf16 v[74:89], v[20:23], v[48:51], v[74:89]
    ds_read_b64_tr_b16 v[12:13], v2 offset:896
    ds_read_b64_tr_b16 v[14:15], v2 offset:1120
    v_mfma_f32_32x32x16_bf16 v[176:191], v[20:23], v[52:55], v[176:191]
    ds_read_b128 v[32:35], v3 offset:43392
    ds_read_b128 v[36:39], v3 offset:44416
    s_cmp_lg_u32 s35, s36
    s_cbranch_scc1 tp_main_kernel_multi2
tp_main_kernel_fin2:
    s_waitcnt lgkmcnt(4)
    v_mfma_f32_32x32x16_bf16 v[192:207], v[8:11], v[24:27], 0
    ds_write_b64 v1, v[128:129] offset:3584
    ds_write_b64 v1, v[130:131] offset:3592
    ds_write_b64 v1, v[132:133] offset:3600
    ds_write_b64 v1, v[134:135] offset:3608
    v_mfma_f32_32x32x16_bf16 v[208:223], v[8:11], v[28:31], 0
    ds_read_b64_tr_b16 v[16:17], v2 offset:1792
    ds_read_b64_tr_b16 v[18:19], v2 offset:2016
    ds_read_b128 v[40:43], v3 offset:53760
    ds_read_b128 v[44:47], v3 offset:54784
    s_waitcnt lgkmcnt(8)
    v_mfma_f32_32x32x16_bf16 v[192:207], v[12:15], v[32:35], v[192:207]
    ds_write_b64 v1, v[136:137] offset:3616
    ds_write_b64 v1, v[138:139] offset:3624
    ds_write_b16 v1, v155 offset:3632
    ds_read_b64_tr_b16 v[20:21], v2 offset:2688
    v_mul_f32 v74, v74, v224
    v_mul_f32 v176, v176, v240
    v_cvt_pk_bf16_f32 v56, v74, v176
    buffer_store_dword v56, v60, s[16:19], 0 offen offset:256 sc1
    v_mul_f32 v75, v75, v225
    v_mfma_f32_32x32x16_bf16 v[208:223], v[12:15], v[36:39], v[208:223]
    ds_read_b64_tr_b16 v[22:23], v2 offset:2912
    ds_read_b128 v[48:51], v3 offset:55808
    ds_read_b128 v[52:55], v3 offset:56832
    v_mul_f32 v177, v177, v241
    v_cvt_pk_bf16_f32 v57, v75, v177
    buffer_store_dword v57, v61, s[16:19], 0 offen offset:256 sc1
    v_mul_f32 v76, v76, v226
    v_mul_f32 v178, v178, v242
    s_waitcnt lgkmcnt(7)
    v_mfma_f32_32x32x16_bf16 v[192:207], v[16:19], v[40:43], v[192:207]
    ds_read_b64_tr_b16 v[8:9], v2 offset:3584
    ds_read_b64_tr_b16 v[10:11], v2 offset:3808
    v_cvt_pk_bf16_f32 v58, v76, v178
    buffer_store_dword v58, v62, s[16:19], 0 offen offset:256 sc1
    v_mul_f32 v77, v77, v227
    v_mul_f32 v179, v179, v243
    v_cvt_pk_bf16_f32 v59, v77, v179
    v_mfma_f32_32x32x16_bf16 v[208:223], v[16:19], v[44:47], v[208:223]
    ds_read_b128 v[24:27], v3 offset:57856
    ds_read_b128 v[28:31], v4 offset:0
    buffer_store_dword v59, v63, s[16:19], 0 offen offset:256 sc1
    v_mul_f32 v78, v78, v228
    v_mul_f32 v180, v180, v244
    v_cvt_pk_bf16_f32 v56, v78, v180
    buffer_store_dword v56, v64, s[16:19], 0 offen offset:256 sc1
    s_waitcnt lgkmcnt(4)
    v_mfma_f32_32x32x16_bf16 v[192:207], v[20:23], v[48:51], v[192:207]
    ds_read_b64_tr_b16 v[12:13], v2 offset:4480
    ds_read_b64_tr_b16 v[14:15], v2 offset:4704
    v_mul_f32 v79, v79, v229
    v_mul_f32 v181, v181, v245
    v_cvt_pk_bf16_f32 v57, v79, v181
    buffer_store_dword v57, v65, s[16:19], 0 offen offset:256 sc1
    v_mul_f32 v80, v80, v230
    v_mfma_f32_32x32x16_bf16 v[208:223], v[20:23], v[52:55], v[208:223]
    ds_read_b128 v[32:35], v4 offset:1024
    ds_read_b128 v[36:39], v4 offset:2048
    v_mul_f32 v182, v182, v246
    v_cvt_pk_bf16_f32 v58, v80, v182
    buffer_store_dword v58, v66, s[16:19], 0 offen offset:256 sc1
    v_mul_f32 v81, v81, v231
    v_mul_f32 v183, v183, v247
    s_waitcnt lgkmcnt(4)
    v_mfma_f32_32x32x16_bf16 v[192:207], v[8:11], v[24:27], v[192:207]
    ds_write_b64 v1, v[140:141] offset:0
    ds_write_b64 v1, v[142:143] offset:8
    ds_write_b64 v1, v[144:145] offset:16
    ds_write_b64 v1, v[146:147] offset:24
    v_cvt_pk_bf16_f32 v59, v81, v183
    buffer_store_dword v59, v67, s[16:19], 0 offen offset:256 sc1
    v_mul_f32 v82, v82, v232
    v_mul_f32 v184, v184, v248
    v_cvt_pk_bf16_f32 v56, v82, v184
    v_mfma_f32_32x32x16_bf16 v[208:223], v[8:11], v[28:31], v[208:223]
    ds_read_b64_tr_b16 v[16:17], v2 offset:5376
    ds_read_b64_tr_b16 v[18:19], v2 offset:5600
    ds_read_b128 v[40:43], v4 offset:3072
    ds_read_b128 v[44:47], v4 offset:4096
    buffer_store_dword v56, v68, s[16:19], 0 offen offset:256 sc1
    v_mul_f32 v83, v83, v233
    v_mul_f32 v185, v185, v249
    v_cvt_pk_bf16_f32 v57, v83, v185
    buffer_store_dword v57, v69, s[16:19], 0 offen offset:256 sc1
    s_setprio 0
    s_cmp_lt_u32 s3, 4
    s_cbranch_scc1 1
    s_setprio 1
    s_waitcnt lgkmcnt(8)
    v_mfma_f32_32x32x16_bf16 v[192:207], v[12:15], v[32:35], v[192:207]
    ds_write_b64 v1, v[148:149] offset:32
    ds_write_b64 v1, v[150:151] offset:40
    ds_write_b16 v1, v153 offset:48
    ds_read_b64_tr_b16 v[20:21], v2 offset:6272
    v_mul_f32 v84, v84, v234
    v_mul_f32 v186, v186, v250
    v_cvt_pk_bf16_f32 v58, v84, v186
    buffer_store_dword v58, v70, s[16:19], 0 offen offset:256 sc1
    v_mul_f32 v85, v85, v235
    v_mfma_f32_32x32x16_bf16 v[208:223], v[12:15], v[36:39], v[208:223]
    ds_read_b64_tr_b16 v[22:23], v2 offset:6496
    ds_read_b128 v[48:51], v4 offset:13440
    ds_read_b128 v[52:55], v4 offset:14464
    v_mul_f32 v187, v187, v251
    v_cvt_pk_bf16_f32 v59, v85, v187
    buffer_store_dword v59, v71, s[16:19], 0 offen offset:256 sc1
    v_mul_f32 v86, v86, v236
    v_mul_f32 v188, v188, v252
    s_waitcnt lgkmcnt(7)
    v_mfma_f32_32x32x16_bf16 v[192:207], v[16:19], v[40:43], v[192:207]
    ds_read_b64_tr_b16 v[8:9], v2 offset:0
    ds_read_b64_tr_b16 v[10:11], v2 offset:224
    v_cvt_pk_bf16_f32 v56, v86, v188
    buffer_store_dword v56, v72, s[16:19], 0 offen offset:256 sc1
    v_mfma_f32_32x32x16_bf16 v[208:223], v[16:19], v[44:47], v[208:223]
    ds_read_b128 v[24:27], v4 offset:15488
    ds_read_b128 v[28:31], v4 offset:16512
    s_waitcnt lgkmcnt(4)
    v_mfma_f32_32x32x16_bf16 v[192:207], v[20:23], v[48:51], v[192:207]
    ds_read_b64_tr_b16 v[12:13], v2 offset:896
    ds_read_b64_tr_b16 v[14:15], v2 offset:1120
    v_mfma_f32_32x32x16_bf16 v[208:223], v[20:23], v[52:55], v[208:223]
    ds_read_b128 v[32:35], v4 offset:17536
    ds_read_b128 v[36:39], v4 offset:26880
    s_waitcnt lgkmcnt(4)
    v_mfma_f32_32x32x16_bf16 v[192:207], v[8:11], v[24:27], v[192:207]
    ds_read_b64_tr_b16 v[16:17], v2 offset:1792
    ds_read_b64_tr_b16 v[18:19], v2 offset:2016
    v_mfma_f32_32x32x16_bf16 v[208:223], v[8:11], v[28:31], v[208:223]
    ds_read_b128 v[40:43], v4 offset:27904
    ds_read_b128 v[44:47], v4 offset:28928
    s_setprio 0
    s_waitcnt lgkmcnt(4)
    v_mfma_f32_32x32x16_bf16 v[192:207], v[12:15], v[32:35], v[192:207]
    ds_read_b64_tr_b16 v[20:21], v2 offset:2688
    ds_read_b64_tr_b16 v[22:23], v2 offset:2912
    v_mfma_f32_32x32x16_bf16 v[208:223], v[12:15], v[36:39], v[208:223]
    ds_read_b128 v[48:51], v4 offset:29952
    ds_read_b128 v[52:55], v4 offset:30976
    s_waitcnt lgkmcnt(4)
    v_mfma_f32_32x32x16_bf16 v[192:207], v[16:19], v[40:43], v[192:207]
    v_mfma_f32_32x32x16_bf16 v[208:223], v[16:19], v[44:47], v[208:223]
    s_waitcnt lgkmcnt(0)
    v_mfma_f32_32x32x16_bf16 v[192:207], v[20:23], v[48:51], v[192:207]
    v_mfma_f32_32x32x16_bf16 v[208:223], v[20:23], v[52:55], v[208:223]
    s_cmp_lg_u32 s35, s36
    s_cbranch_scc1 tp_main_kernel_multi3
tp_main_kernel_fin3:
    s_nop 9
    v_mul_f32 v192, v192, v224
    v_mul_f32 v208, v208, v240
    v_cvt_pk_bf16_f32 v56, v192, v208
    buffer_store_dword v56, v60, s[16:19], 0 offen offset:384 sc1
    v_mul_f32 v193, v193, v225
    v_mul_f32 v209, v209, v241
    v_cvt_pk_bf16_f32 v57, v193, v209
    buffer_store_dword v57, v61, s[16:19], 0 offen offset:384 sc1
    v_mul_f32 v194, v194, v226
    v_mul_f32 v210, v210, v242
    v_cvt_pk_bf16_f32 v58, v194, v210
    buffer_store_dword v58, v62, s[16:19], 0 offen offset:384 sc1
    v_mul_f32 v195, v195, v227
    v_mul_f32 v211, v211, v243
    v_cvt_pk_bf16_f32 v59, v195, v211
    buffer_store_dword v59, v63, s[16:19], 0 offen offset:384 sc1
    v_mul_f32 v196, v196, v228
    v_mul_f32 v212, v212, v244
    v_cvt_pk_bf16_f32 v56, v196, v212
    buffer_store_dword v56, v64, s[16:19], 0 offen offset:384 sc1
    v_mul_f32 v197, v197, v229
    v_mul_f32 v213, v213, v245
    v_cvt_pk_bf16_f32 v57, v197, v213
    buffer_store_dword v57, v65, s[16:19], 0 offen offset:384 sc1
    v_mul_f32 v198, v198, v230
    v_mul_f32 v214, v214, v246
    v_cvt_pk_bf16_f32 v58, v198, v214
    buffer_store_dword v58, v66, s[16:19], 0 offen offset:384 sc1
    v_mul_f32 v199, v199, v231
    v_mul_f32 v215, v215, v247
    v_cvt_pk_bf16_f32 v59, v199, v215
    buffer_store_dword v59, v67, s[16:19], 0 offen offset:384 sc1
    v_mul_f32 v200, v200, v232
    v_mul_f32 v216, v216, v248
    v_cvt_pk_bf16_f32 v56, v200, v216
    buffer_store_dword v56, v68, s[16:19], 0 offen offset:384 sc1
    v_mul_f32 v201, v201, v233
    v_mul_f32 v217, v217, v249
    v_cvt_pk_bf16_f32 v57, v201, v217
    buffer_store_dword v57, v69, s[16:19], 0 offen offset:384 sc1
    v_mul_f32 v202, v202, v234
    v_mul_f32 v218, v218, v250
    v_cvt_pk_bf16_f32 v58, v202, v218
    buffer_store_dword v58, v70, s[16:19], 0 offen offset:384 sc1
    v_mul_f32 v203, v203, v235
    v_mul_f32 v219, v219, v251
    v_cvt_pk_bf16_f32 v59, v203, v219
    buffer_store_dword v59, v71, s[16:19], 0 offen offset:384 sc1
    v_mul_f32 v204, v204, v236
    v_mul_f32 v220, v220, v252
    v_cvt_pk_bf16_f32 v56, v204, v220
    buffer_store_dword v56, v72, s[16:19], 0 offen offset:384 sc1
tp_main_kernel_next3:
    s_cmp_ge_u32 s50, s35
    s_cbranch_scc1 tp_main_kernel_end
    s_mov_b32 s34, s50
    s_setprio 0
    s_waitcnt vmcnt(0) lgkmcnt(0)
    s_barrier
    s_branch tp_main_kernel_window
tp_main_kernel_multi0:
    s_nop 15
    v_lshrrev_b32 v7, 2, v0
    s_add_u32 s48, s51, 0
    s_add_u32 s49, s48, 4096
    s_cmp_eq_u32 s34, 0
    s_cbranch_scc1 tp_main_kernel_mst0
    buffer_load_dword v56, v7, s[28:31], s48 offen offset:0 sc1
    s_waitcnt vmcnt(0)
    v_add_f32 v224, v224, v56
    buffer_load_dword v56, v7, s[28:31], s48 offen offset:256 sc1
    s_waitcnt vmcnt(0)
    v_add_f32 v225, v225, v56
    buffer_load_dword v56, v7, s[28:31], s48 offen offset:512 sc1
    s_waitcnt vmcnt(0)
    v_add_f32 v226, v226, v56
    buffer_load_dword v56, v7, s[28:31], s48 offen offset:768 sc1
    s_waitcnt vmcnt(0)
    v_add_f32 v227, v227, v56
    buffer_load_dword v56, v7, s[28:31], s48 offen offset:1024 sc1
    s_waitcnt vmcnt(0)
    v_add_f32 v228, v228, v56
    buffer_load_dword v56, v7, s[28:31], s48 offen offset:1280 sc1
    s_waitcnt vmcnt(0)
    v_add_f32 v229, v229, v56
    buffer_load_dword v56, v7, s[28:31], s48 offen offset:1536 sc1
    s_waitcnt vmcnt(0)
    v_add_f32 v230, v230, v56
    buffer_load_dword v56, v7, s[28:31], s48 offen offset:1792 sc1
    s_waitcnt vmcnt(0)
    v_add_f32 v231, v231, v56
    buffer_load_dword v56, v7, s[28:31], s48 offen offset:2048 sc1
    s_waitcnt vmcnt(0)
    v_add_f32 v232, v232, v56
    buffer_load_dword v56, v7, s[28:31], s48 offen offset:2304 sc1
    s_waitcnt vmcnt(0)
    v_add_f32 v233, v233, v56
    buffer_load_dword v56, v7, s[28:31], s48 offen offset:2560 sc1
    s_waitcnt vmcnt(0)
    v_add_f32 v234, v234, v56
    buffer_load_dword v56, v7, s[28:31], s48 offen offset:2816 sc1
    s_waitcnt vmcnt(0)
    v_add_f32 v235, v235, v56
    buffer_load_dword v56, v7, s[28:31], s48 offen offset:3072 sc1
    s_waitcnt vmcnt(0)
    v_add_f32 v236, v236, v56
    buffer_load_dword v56, v7, s[28:31], s49 offen offset:0 sc1
    s_waitcnt vmcnt(0)
    v_add_f32 v240, v240, v56
    buffer_load_dword v56, v7, s[28:31], s49 offen offset:256 sc1
    s_waitcnt vmcnt(0)
    v_add_f32 v241, v241, v56
    buffer_load_dword v56, v7, s[28:31], s49 offen offset:512 sc1
    s_waitcnt vmcnt(0)
    v_add_f32 v242, v242, v56
    buffer_load_dword v56, v7, s[28:31], s49 offen offset:768 sc1
    s_waitcnt vmcnt(0)
    v_add_f32 v243, v243, v56
    buffer_load_dword v56, v7, s[28:31], s49 offen offset:1024 sc1
    s_waitcnt vmcnt(0)
    v_add_f32 v244, v244, v56
    buffer_load_dword v56, v7, s[28:31], s49 offen offset:1280 sc1
    s_waitcnt vmcnt(0)
    v_add_f32 v245, v245, v56
    buffer_load_dword v56, v7, s[28:31], s49 offen offset:1536 sc1
    s_waitcnt vmcnt(0)
    v_add_f32 v246, v246, v56
    buffer_load_dword v56, v7, s[28:31], s49 offen offset:1792 sc1
    s_waitcnt vmcnt(0)
    v_add_f32 v247, v247, v56
    buffer_load_dword v56, v7, s[28:31], s49 offen offset:2048 sc1
    s_waitcnt vmcnt(0)
    v_add_f32 v248, v248, v56
    buffer_load_dword v56, v7, s[28:31], s49 offen offset:2304 sc1
    s_waitcnt vmcnt(0)
    v_add_f32 v249, v249, v56
    buffer_load_dword v56, v7, s[28:31], s49 offen offset:2560 sc1
    s_waitcnt vmcnt(0)
    v_add_f32 v250, v250, v56
    buffer_load_dword v56, v7, s[28:31], s49 offen offset:2816 sc1
    s_waitcnt vmcnt(0)
    v_add_f32 v251, v251, v56
    buffer_load_dword v56, v7, s[28:31], s49 offen offset:3072 sc1
    s_waitcnt vmcnt(0)
    v_add_f32 v252, v252, v56
tp_main_kernel_mst0:
    buffer_store_dword v224, v7, s[28:31], s48 offen offset:0
    buffer_store_dword v225, v7, s[28:31], s48 offen offset:256
    buffer_store_dword v226, v7, s[28:31], s48 offen offset:512
    buffer_store_dword v227, v7, s[28:31], s48 offen offset:768
    buffer_store_dword v228, v7, s[28:31], s48 offen offset:1024
    buffer_store_dword v229, v7, s[28:31], s48 offen offset:1280
    buffer_store_dword v230, v7, s[28:31], s48 offen offset:1536
    buffer_store_dword v231, v7, s[28:31], s48 offen offset:1792
    buffer_store_dword v232, v7, s[28:31], s48 offen offset:2048
    buffer_store_dword v233, v7, s[28:31], s48 offen offset:2304
    buffer_store_dword v234, v7, s[28:31], s48 offen offset:2560
    buffer_store_dword v235, v7, s[28:31], s48 offen offset:2816
    buffer_store_dword v236, v7, s[28:31], s48 offen offset:3072
    buffer_store_dword v240, v7, s[28:31], s49 offen offset:0
    buffer_store_dword v241, v7, s[28:31], s49 offen offset:256
    buffer_store_dword v242, v7, s[28:31], s49 offen offset:512
    buffer_store_dword v243, v7, s[28:31], s49 offen offset:768
    buffer_store_dword v244, v7, s[28:31], s49 offen offset:1024
    buffer_store_dword v245, v7, s[28:31], s49 offen offset:1280
    buffer_store_dword v246, v7, s[28:31], s49 offen offset:1536
    buffer_store_dword v247, v7, s[28:31], s49 offen offset:1792
    buffer_store_dword v248, v7, s[28:31], s49 offen offset:2048
    buffer_store_dword v249, v7, s[28:31], s49 offen offset:2304
    buffer_store_dword v250, v7, s[28:31], s49 offen offset:2560
    buffer_store_dword v251, v7, s[28:31], s49 offen offset:2816
    buffer_store_dword v252, v7, s[28:31], s49 offen offset:3072
    s_waitcnt vmcnt(0)
    s_branch tp_main_kernel_fin0
tp_main_kernel_multi1:
    s_nop 15
    v_lshrrev_b32 v7, 2, v0
    s_add_u32 s48, s51, 8192
    s_add_u32 s49, s48, 4096
    s_cmp_eq_u32 s34, 0
    s_cbranch_scc1 tp_main_kernel_mst1
    buffer_load_dword v56, v7, s[28:31], s48 offen offset:0 sc1
    s_waitcnt vmcnt(0)
    v_add_f32 v192, v192, v56
    buffer_load_dword v56, v7, s[28:31], s48 offen offset:256 sc1
    s_waitcnt vmcnt(0)
    v_add_f32 v193, v193, v56
    buffer_load_dword v56, v7, s[28:31], s48 offen offset:512 sc1
    s_waitcnt vmcnt(0)
    v_add_f32 v194, v194, v56
    buffer_load_dword v56, v7, s[28:31], s48 offen offset:768 sc1
    s_waitcnt vmcnt(0)
    v_add_f32 v195, v195, v56
    buffer_load_dword v56, v7, s[28:31], s48 offen offset:1024 sc1
    s_waitcnt vmcnt(0)
    v_add_f32 v196, v196, v56
    buffer_load_dword v56, v7, s[28:31], s48 offen offset:1280 sc1
    s_waitcnt vmcnt(0)
    v_add_f32 v197, v197, v56
    buffer_load_dword v56, v7, s[28:31], s48 offen offset:1536 sc1
    s_waitcnt vmcnt(0)
    v_add_f32 v198, v198, v56
    buffer_load_dword v56, v7, s[28:31], s48 offen offset:1792 sc1
    s_waitcnt vmcnt(0)
    v_add_f32 v199, v199, v56
    buffer_load_dword v56, v7, s[28:31], s48 offen offset:2048 sc1
    s_waitcnt vmcnt(0)
    v_add_f32 v200, v200, v56
    buffer_load_dword v56, v7, s[28:31], s48 offen offset:2304 sc1
    s_waitcnt vmcnt(0)
    v_add_f32 v201, v201, v56
    buffer_load_dword v56, v7, s[28:31], s48 offen offset:2560 sc1
    s_waitcnt vmcnt(0)
    v_add_f32 v202, v202, v56
    buffer_load_dword v56, v7, s[28:31], s48 offen offset:2816 sc1
    s_waitcnt vmcnt(0)
    v_add_f32 v203, v203, v56
    buffer_load_dword v56, v7, s[28:31], s48 offen offset:3072 sc1
    s_waitcnt vmcnt(0)
    v_add_f32 v204, v204, v56
    buffer_load_dword v56, v7, s[28:31], s49 offen offset:0 sc1
    s_waitcnt vmcnt(0)
    v_add_f32 v208, v208, v56
    buffer_load_dword v56, v7, s[28:31], s49 offen offset:256 sc1
    s_waitcnt vmcnt(0)
    v_add_f32 v209, v209, v56
    buffer_load_dword v56, v7, s[28:31], s49 offen offset:512 sc1
    s_waitcnt vmcnt(0)
    v_add_f32 v210, v210, v56
    buffer_load_dword v56, v7, s[28:31], s49 offen offset:768 sc1
    s_waitcnt vmcnt(0)
    v_add_f32 v211, v211, v56
    buffer_load_dword v56, v7, s[28:31], s49 offen offset:1024 sc1
    s_waitcnt vmcnt(0)
    v_add_f32 v212, v212, v56
    buffer_load_dword v56, v7, s[28:31], s49 offen offset:1280 sc1
    s_waitcnt vmcnt(0)
    v_add_f32 v213, v213, v56
    buffer_load_dword v56, v7, s[28:31], s49 offen offset:1536 sc1
    s_waitcnt vmcnt(0)
    v_add_f32 v214, v214, v56
    buffer_load_dword v56, v7, s[28:31], s49 offen offset:1792 sc1
    s_waitcnt vmcnt(0)
    v_add_f32 v215, v215, v56
    buffer_load_dword v56, v7, s[28:31], s49 offen offset:2048 sc1
    s_waitcnt vmcnt(0)
    v_add_f32 v216, v216, v56
    buffer_load_dword v56, v7, s[28:31], s49 offen offset:2304 sc1
    s_waitcnt vmcnt(0)
    v_add_f32 v217, v217, v56
    buffer_load_dword v56, v7, s[28:31], s49 offen offset:2560 sc1
    s_waitcnt vmcnt(0)
    v_add_f32 v218, v218, v56
    buffer_load_dword v56, v7, s[28:31], s49 offen offset:2816 sc1
    s_waitcnt vmcnt(0)
    v_add_f32 v219, v219, v56
    buffer_load_dword v56, v7, s[28:31], s49 offen offset:3072 sc1
    s_waitcnt vmcnt(0)
    v_add_f32 v220, v220, v56
tp_main_kernel_mst1:
    buffer_store_dword v192, v7, s[28:31], s48 offen offset:0
    buffer_store_dword v193, v7, s[28:31], s48 offen offset:256
    buffer_store_dword v194, v7, s[28:31], s48 offen offset:512
    buffer_store_dword v195, v7, s[28:31], s48 offen offset:768
    buffer_store_dword v196, v7, s[28:31], s48 offen offset:1024
    buffer_store_dword v197, v7, s[28:31], s48 offen offset:1280
    buffer_store_dword v198, v7, s[28:31], s48 offen offset:1536
    buffer_store_dword v199, v7, s[28:31], s48 offen offset:1792
    buffer_store_dword v200, v7, s[28:31], s48 offen offset:2048
    buffer_store_dword v201, v7, s[28:31], s48 offen offset:2304
    buffer_store_dword v202, v7, s[28:31], s48 offen offset:2560
    buffer_store_dword v203, v7, s[28:31], s48 offen offset:2816
    buffer_store_dword v204, v7, s[28:31], s48 offen offset:3072
    buffer_store_dword v208, v7, s[28:31], s49 offen offset:0
    buffer_store_dword v209, v7, s[28:31], s49 offen offset:256
    buffer_store_dword v210, v7, s[28:31], s49 offen offset:512
    buffer_store_dword v211, v7, s[28:31], s49 offen offset:768
    buffer_store_dword v212, v7, s[28:31], s49 offen offset:1024
    buffer_store_dword v213, v7, s[28:31], s49 offen offset:1280
    buffer_store_dword v214, v7, s[28:31], s49 offen offset:1536
    buffer_store_dword v215, v7, s[28:31], s49 offen offset:1792
    buffer_store_dword v216, v7, s[28:31], s49 offen offset:2048
    buffer_store_dword v217, v7, s[28:31], s49 offen offset:2304
    buffer_store_dword v218, v7, s[28:31], s49 offen offset:2560
    buffer_store_dword v219, v7, s[28:31], s49 offen offset:2816
    buffer_store_dword v220, v7, s[28:31], s49 offen offset:3072
    s_waitcnt vmcnt(0)
    s_branch tp_main_kernel_fin1
tp_main_kernel_multi2:
    s_nop 15
    v_lshrrev_b32 v7, 2, v0
    s_add_u32 s48, s51, 16384
    s_add_u32 s49, s48, 4096
    s_cmp_eq_u32 s34, 0
    s_cbranch_scc1 tp_main_kernel_mst2
    buffer_load_dword v56, v7, s[28:31], s48 offen offset:0 sc1
    s_waitcnt vmcnt(0)
    v_add_f32 v74, v74, v56
    buffer_load_dword v56, v7, s[28:31], s48 offen offset:256 sc1
    s_waitcnt vmcnt(0)
    v_add_f32 v75, v75, v56
    buffer_load_dword v56, v7, s[28:31], s48 offen offset:512 sc1
    s_waitcnt vmcnt(0)
    v_add_f32 v76, v76, v56
    buffer_load_dword v56, v7, s[28:31], s48 offen offset:768 sc1
    s_waitcnt vmcnt(0)
    v_add_f32 v77, v77, v56
    buffer_load_dword v56, v7, s[28:31], s48 offen offset:1024 sc1
    s_waitcnt vmcnt(0)
    v_add_f32 v78, v78, v56
    buffer_load_dword v56, v7, s[28:31], s48 offen offset:1280 sc1
    s_waitcnt vmcnt(0)
    v_add_f32 v79, v79, v56
    buffer_load_dword v56, v7, s[28:31], s48 offen offset:1536 sc1
    s_waitcnt vmcnt(0)
    v_add_f32 v80, v80, v56
    buffer_load_dword v56, v7, s[28:31], s48 offen offset:1792 sc1
    s_waitcnt vmcnt(0)
    v_add_f32 v81, v81, v56
    buffer_load_dword v56, v7, s[28:31], s48 offen offset:2048 sc1
    s_waitcnt vmcnt(0)
    v_add_f32 v82, v82, v56
    buffer_load_dword v56, v7, s[28:31], s48 offen offset:2304 sc1
    s_waitcnt vmcnt(0)
    v_add_f32 v83, v83, v56
    buffer_load_dword v56, v7, s[28:31], s48 offen offset:2560 sc1
    s_waitcnt vmcnt(0)
    v_add_f32 v84, v84, v56
    buffer_load_dword v56, v7, s[28:31], s48 offen offset:2816 sc1
    s_waitcnt vmcnt(0)
    v_add_f32 v85, v85, v56
    buffer_load_dword v56, v7, s[28:31], s48 offen offset:3072 sc1
    s_waitcnt vmcnt(0)
    v_add_f32 v86, v86, v56
    buffer_load_dword v56, v7, s[28:31], s49 offen offset:0 sc1
    s_waitcnt vmcnt(0)
    v_add_f32 v176, v176, v56
    buffer_load_dword v56, v7, s[28:31], s49 offen offset:256 sc1
    s_waitcnt vmcnt(0)
    v_add_f32 v177, v177, v56
    buffer_load_dword v56, v7, s[28:31], s49 offen offset:512 sc1
    s_waitcnt vmcnt(0)
    v_add_f32 v178, v178, v56
    buffer_load_dword v56, v7, s[28:31], s49 offen offset:768 sc1
    s_waitcnt vmcnt(0)
    v_add_f32 v179, v179, v56
    buffer_load_dword v56, v7, s[28:31], s49 offen offset:1024 sc1
    s_waitcnt vmcnt(0)
    v_add_f32 v180, v180, v56
    buffer_load_dword v56, v7, s[28:31], s49 offen offset:1280 sc1
    s_waitcnt vmcnt(0)
    v_add_f32 v181, v181, v56
    buffer_load_dword v56, v7, s[28:31], s49 offen offset:1536 sc1
    s_waitcnt vmcnt(0)
    v_add_f32 v182, v182, v56
    buffer_load_dword v56, v7, s[28:31], s49 offen offset:1792 sc1
    s_waitcnt vmcnt(0)
    v_add_f32 v183, v183, v56
    buffer_load_dword v56, v7, s[28:31], s49 offen offset:2048 sc1
    s_waitcnt vmcnt(0)
    v_add_f32 v184, v184, v56
    buffer_load_dword v56, v7, s[28:31], s49 offen offset:2304 sc1
    s_waitcnt vmcnt(0)
    v_add_f32 v185, v185, v56
    buffer_load_dword v56, v7, s[28:31], s49 offen offset:2560 sc1
    s_waitcnt vmcnt(0)
    v_add_f32 v186, v186, v56
    buffer_load_dword v56, v7, s[28:31], s49 offen offset:2816 sc1
    s_waitcnt vmcnt(0)
    v_add_f32 v187, v187, v56
    buffer_load_dword v56, v7, s[28:31], s49 offen offset:3072 sc1
    s_waitcnt vmcnt(0)
    v_add_f32 v188, v188, v56
tp_main_kernel_mst2:
    buffer_store_dword v74, v7, s[28:31], s48 offen offset:0
    buffer_store_dword v75, v7, s[28:31], s48 offen offset:256
    buffer_store_dword v76, v7, s[28:31], s48 offen offset:512
    buffer_store_dword v77, v7, s[28:31], s48 offen offset:768
    buffer_store_dword v78, v7, s[28:31], s48 offen offset:1024
    buffer_store_dword v79, v7, s[28:31], s48 offen offset:1280
    buffer_store_dword v80, v7, s[28:31], s48 offen offset:1536
    buffer_store_dword v81, v7, s[28:31], s48 offen offset:1792
    buffer_store_dword v82, v7, s[28:31], s48 offen offset:2048
    buffer_store_dword v83, v7, s[28:31], s48 offen offset:2304
    buffer_store_dword v84, v7, s[28:31], s48 offen offset:2560
    buffer_store_dword v85, v7, s[28:31], s48 offen offset:2816
    buffer_store_dword v86, v7, s[28:31], s48 offen offset:3072
    buffer_store_dword v176, v7, s[28:31], s49 offen offset:0
    buffer_store_dword v177, v7, s[28:31], s49 offen offset:256
    buffer_store_dword v178, v7, s[28:31], s49 offen offset:512
    buffer_store_dword v179, v7, s[28:31], s49 offen offset:768
    buffer_store_dword v180, v7, s[28:31], s49 offen offset:1024
    buffer_store_dword v181, v7, s[28:31], s49 offen offset:1280
    buffer_store_dword v182, v7, s[28:31], s49 offen offset:1536
    buffer_store_dword v183, v7, s[28:31], s49 offen offset:1792
    buffer_store_dword v184, v7, s[28:31], s49 offen offset:2048
    buffer_store_dword v185, v7, s[28:31], s49 offen offset:2304
    buffer_store_dword v186, v7, s[28:31], s49 offen offset:2560
    buffer_store_dword v187, v7, s[28:31], s49 offen offset:2816
    buffer_store_dword v188, v7, s[28:31], s49 offen offset:3072
    s_waitcnt vmcnt(0)
    s_branch tp_main_kernel_fin2
tp_main_kernel_multi3:
    s_nop 15
    v_lshrrev_b32 v7, 2, v0
    s_add_u32 s48, s51, 24576
    s_add_u32 s49, s48, 4096
    s_cmp_eq_u32 s34, 0
    s_cbranch_scc1 tp_main_kernel_mst3
    buffer_load_dword v56, v7, s[28:31], s48 offen offset:0 sc1
    s_waitcnt vmcnt(0)
    v_add_f32 v192, v192, v56
    buffer_load_dword v56, v7, s[28:31], s48 offen offset:256 sc1
    s_waitcnt vmcnt(0)
    v_add_f32 v193, v193, v56
    buffer_load_dword v56, v7, s[28:31], s48 offen offset:512 sc1
    s_waitcnt vmcnt(0)
    v_add_f32 v194, v194, v56
    buffer_load_dword v56, v7, s[28:31], s48 offen offset:768 sc1
    s_waitcnt vmcnt(0)
    v_add_f32 v195, v195, v56
    buffer_load_dword v56, v7, s[28:31], s48 offen offset:1024 sc1
    s_waitcnt vmcnt(0)
    v_add_f32 v196, v196, v56
    buffer_load_dword v56, v7, s[28:31], s48 offen offset:1280 sc1
    s_waitcnt vmcnt(0)
    v_add_f32 v197, v197, v56
    buffer_load_dword v56, v7, s[28:31], s48 offen offset:1536 sc1
    s_waitcnt vmcnt(0)
    v_add_f32 v198, v198, v56
    buffer_load_dword v56, v7, s[28:31], s48 offen offset:1792 sc1
    s_waitcnt vmcnt(0)
    v_add_f32 v199, v199, v56
    buffer_load_dword v56, v7, s[28:31], s48 offen offset:2048 sc1
    s_waitcnt vmcnt(0)
    v_add_f32 v200, v200, v56
    buffer_load_dword v56, v7, s[28:31], s48 offen offset:2304 sc1
    s_waitcnt vmcnt(0)
    v_add_f32 v201, v201, v56
    buffer_load_dword v56, v7, s[28:31], s48 offen offset:2560 sc1
    s_waitcnt vmcnt(0)
    v_add_f32 v202, v202, v56
    buffer_load_dword v56, v7, s[28:31], s48 offen offset:2816 sc1
    s_waitcnt vmcnt(0)
    v_add_f32 v203, v203, v56
    buffer_load_dword v56, v7, s[28:31], s48 offen offset:3072 sc1
    s_waitcnt vmcnt(0)
    v_add_f32 v204, v204, v56
    buffer_load_dword v56, v7, s[28:31], s49 offen offset:0 sc1
    s_waitcnt vmcnt(0)
    v_add_f32 v208, v208, v56
    buffer_load_dword v56, v7, s[28:31], s49 offen offset:256 sc1
    s_waitcnt vmcnt(0)
    v_add_f32 v209, v209, v56
    buffer_load_dword v56, v7, s[28:31], s49 offen offset:512 sc1
    s_waitcnt vmcnt(0)
    v_add_f32 v210, v210, v56
    buffer_load_dword v56, v7, s[28:31], s49 offen offset:768 sc1
    s_waitcnt vmcnt(0)
    v_add_f32 v211, v211, v56
    buffer_load_dword v56, v7, s[28:31], s49 offen offset:1024 sc1
    s_waitcnt vmcnt(0)
    v_add_f32 v212, v212, v56
    buffer_load_dword v56, v7, s[28:31], s49 offen offset:1280 sc1
    s_waitcnt vmcnt(0)
    v_add_f32 v213, v213, v56
    buffer_load_dword v56, v7, s[28:31], s49 offen offset:1536 sc1
    s_waitcnt vmcnt(0)
    v_add_f32 v214, v214, v56
    buffer_load_dword v56, v7, s[28:31], s49 offen offset:1792 sc1
    s_waitcnt vmcnt(0)
    v_add_f32 v215, v215, v56
    buffer_load_dword v56, v7, s[28:31], s49 offen offset:2048 sc1
    s_waitcnt vmcnt(0)
    v_add_f32 v216, v216, v56
    buffer_load_dword v56, v7, s[28:31], s49 offen offset:2304 sc1
    s_waitcnt vmcnt(0)
    v_add_f32 v217, v217, v56
    buffer_load_dword v56, v7, s[28:31], s49 offen offset:2560 sc1
    s_waitcnt vmcnt(0)
    v_add_f32 v218, v218, v56
    buffer_load_dword v56, v7, s[28:31], s49 offen offset:2816 sc1
    s_waitcnt vmcnt(0)
    v_add_f32 v219, v219, v56
    buffer_load_dword v56, v7, s[28:31], s49 offen offset:3072 sc1
    s_waitcnt vmcnt(0)
    v_add_f32 v220, v220, v56
tp_main_kernel_mst3:
    buffer_store_dword v192, v7, s[28:31], s48 offen offset:0
    buffer_store_dword v193, v7, s[28:31], s48 offen offset:256
    buffer_store_dword v194, v7, s[28:31], s48 offen offset:512
    buffer_store_dword v195, v7, s[28:31], s48 offen offset:768
    buffer_store_dword v196, v7, s[28:31], s48 offen offset:1024
    buffer_store_dword v197, v7, s[28:31], s48 offen offset:1280
    buffer_store_dword v198, v7, s[28:31], s48 offen offset:1536
    buffer_store_dword v199, v7, s[28:31], s48 offen offset:1792
    buffer_store_dword v200, v7, s[28:31], s48 offen offset:2048
    buffer_store_dword v201, v7, s[28:31], s48 offen offset:2304
    buffer_store_dword v202, v7, s[28:31], s48 offen offset:2560
    buffer_store_dword v203, v7, s[28:31], s48 offen offset:2816
    buffer_store_dword v204, v7, s[28:31], s48 offen offset:3072
    buffer_store_dword v208, v7, s[28:31], s49 offen offset:0
    buffer_store_dword v209, v7, s[28:31], s49 offen offset:256
    buffer_store_dword v210, v7, s[28:31], s49 offen offset:512
    buffer_store_dword v211, v7, s[28:31], s49 offen offset:768
    buffer_store_dword v212, v7, s[28:31], s49 offen offset:1024
    buffer_store_dword v213, v7, s[28:31], s49 offen offset:1280
    buffer_store_dword v214, v7, s[28:31], s49 offen offset:1536
    buffer_store_dword v215, v7, s[28:31], s49 offen offset:1792
    buffer_store_dword v216, v7, s[28:31], s49 offen offset:2048
    buffer_store_dword v217, v7, s[28:31], s49 offen offset:2304
    buffer_store_dword v218, v7, s[28:31], s49 offen offset:2560
    buffer_store_dword v219, v7, s[28:31], s49 offen offset:2816
    buffer_store_dword v220, v7, s[28:31], s49 offen offset:3072
    s_waitcnt vmcnt(0)
    s_branch tp_main_kernel_fin3
tp_main_kernel_end:
    s_endpgm
.section .rodata,"a"
.p2align 6
.amdhsa_kernel tp_sort_kernel
  .amdhsa_next_free_vgpr 64
  .amdhsa_next_free_sgpr 102
  .amdhsa_accum_offset 64
  .amdhsa_group_segment_fixed_size 0
  .amdhsa_kernarg_size 96
  .amdhsa_user_sgpr_count 2
  .amdhsa_user_sgpr_kernarg_segment_ptr 1
  .amdhsa_system_sgpr_workgroup_id_x 1
  .amdhsa_float_denorm_mode_32 3
.end_amdhsa_kernel
.p2align 6
.amdhsa_kernel tp_main_kernel
  .amdhsa_next_free_vgpr 256
  .amdhsa_next_free_sgpr 102
  .amdhsa_accum_offset 256
  .amdhsa_group_segment_fixed_size 0
  .amdhsa_kernarg_size 96
  .amdhsa_user_sgpr_count 2
  .amdhsa_user_sgpr_kernarg_segment_ptr 1
  .amdhsa_system_sgpr_workgroup_id_x 1
  .amdhsa_float_denorm_mode_32 3
.end_amdhsa_kernel
```
